```python
import torch

def _softmax(x, axis=-1):
    return torch.softmax(x, dim=axis)
def _gelu(x):
    return torch.nn.functional.gelu(x, approximate="tanh")
def _silu(x):
    return torch.nn.functional.silu(x)
def _sigmoid(x):
    return torch.sigmoid(x)
def _layernorm(x, axis=-1, eps=1e-5):
    m = x.mean(dim=axis, keepdim=True)
    v = x.var(dim=axis, keepdim=True, unbiased=False)
    return (x - m) / torch.sqrt(v + eps)
def _scatter_add(tgt, idx, src, axis=0):
    return tgt.clone().index_add_(axis, idx, src)
def _segment_sum(src, seg, n):
    out = torch.zeros((n,) + src.shape[1:], dtype=src.dtype)
    return out.index_add_(0, seg, src)
def _pad(x, pw):
    flat = tuple(v for pair in reversed(pw) for v in pair)
    return torch.nn.functional.pad(x, flat)

kernel_name = 'standalone__gqa_softmax__near_ridge'

def setup_inputs():

    _w = (lambda a: (lambda t: t.to(torch.bfloat16) if t.is_floating_point() else t)(torch.as_tensor(a)))
    B, Hq, Hkv, Sq, Sk, D = 8, 32, 8, 144, 1024, 128
    return {
        "q": _w((lambda *s: torch.randn(*s, dtype=torch.bfloat16) * 0.8)(B, Hq, Sq, D)),
        "k": _w((lambda *s: torch.randn(*s, dtype=torch.bfloat16) * 0.8)(B, Hkv, Sk, D)),
        "v": _w((lambda *s: torch.randn(*s, dtype=torch.bfloat16) * 0.05)(B, Hkv, Sk, D)),
    }

def reference(q, k, v):
    B, Hq, Sq, D = q.shape
    Hkv = k.shape[1]
    rep = Hq // Hkv
    k = (lambda x, n, axis: torch.repeat_interleave(x, n, dim=axis))(k, rep, axis=1)
    v = (lambda x, n, axis: torch.repeat_interleave(x, n, dim=axis))(v, rep, axis=1)
    scale = D ** -0.5
    scores = torch.einsum("bhqd,bhkd->bhqk", q, k) * scale
    p = _softmax(scores, axis=-1)
    return torch.einsum("bhqk,bhkd->bhqd", p, v)
```

```asm
; @launch grid=(256,1,1) block=(512,1,1) lds=137216
.amdgcn_target "amdgcn-amd-amdhsa--gfx950"
.text
.globl standalone__gqa_softmax__near_ridge_kernel
.p2align 8
.type standalone__gqa_softmax__near_ridge_kernel,@function
standalone__gqa_softmax__near_ridge_kernel:
  s_cmp_ge_u32 s2, 256
  s_cbranch_scc1 L_end
  s_load_dwordx4 s[4:7], s[0:1], 0
  s_load_dwordx4 s[28:31], s[0:1], 16
  v_lshrrev_b32 v1, 6, v0
  s_and_b32 s32, s2, 7
  v_readfirstlane_b32 s3, v1
  v_and_b32 v1, 63, v0
  s_lshr_b32 s33, s2, 5
  s_lshl_b32 s33, s33, 3
  s_add_u32 s32, s32, s33
  s_lshr_b32 s33, s2, 3
  s_and_b32 s33, s33, 3
  s_lshl_b32 s34, s32, 2
  s_add_u32 s34, s34, s33
  s_mul_i32 s35, s34, 36864
  s_lshl_b32 s36, s32, 18
  s_mov_b32 s37, 0x3e0293ee
  s_mov_b32 s49, 0x53800000
  v_lshrrev_b32 v2, 4, v1
  v_and_b32 v3, 7, v1
  v_xor_b32 v2, v2, v3
  v_lshlrev_b32 v2, 4, v2
  v_lshrrev_b32 v3, 3, v1
  v_lshl_add_u32 v14, v3, 8, v2
  v_xor_b32 v15, 64, v14
  s_waitcnt lgkmcnt(0)
  s_mov_b32 s8, s4
  s_and_b32 s9, s5, 0xffff
  s_mov_b32 s10, 9437184
  s_mov_b32 s11, 0x20000
  s_mov_b32 s12, s6
  s_and_b32 s13, s7, 0xffff
  s_mov_b32 s14, 16777216
  s_mov_b32 s15, 0x20000
  s_mov_b32 s16, s28
  s_and_b32 s17, s29, 0xffff
  s_mov_b32 s18, 16777216
  s_mov_b32 s19, 0x20000
  s_mov_b32 s20, s30
  s_and_b32 s21, s31, 0xffff
  s_mov_b32 s22, 9437184
  s_mov_b32 s23, 0x20000
  s_cmp_ge_u32 s3, 4
  s_cbranch_scc1 L_helper
  s_lshl_b32 s46, s3, 13
  s_add_u32 s47, s46, s35
  s_add_u32 s48, s46, 0x18000
  s_add_u32 m0, s48, 0
  s_add_u32 s51, s47, 0
  buffer_load_dwordx4 v14, s[8:11], s51 offen nt lds
  s_add_u32 m0, s48, 1024
  s_add_u32 s51, s47, 2048
  buffer_load_dwordx4 v15, s[8:11], s51 offen nt lds
  s_add_u32 m0, s48, 2048
  s_add_u32 s51, s47, 4096
  buffer_load_dwordx4 v14, s[8:11], s51 offen nt lds
  s_add_u32 m0, s48, 3072
  s_add_u32 s51, s47, 6144
  buffer_load_dwordx4 v15, s[8:11], s51 offen nt lds
  s_add_u32 m0, s48, 4096
  s_add_u32 s51, s47, 128
  buffer_load_dwordx4 v14, s[8:11], s51 offen nt lds
  s_add_u32 m0, s48, 5120
  s_add_u32 s51, s47, 2176
  buffer_load_dwordx4 v15, s[8:11], s51 offen nt lds
  s_add_u32 m0, s48, 6144
  s_add_u32 s51, s47, 4224
  buffer_load_dwordx4 v14, s[8:11], s51 offen nt lds
  s_add_u32 m0, s48, 7168
  s_add_u32 s51, s47, 6272
  buffer_load_dwordx4 v15, s[8:11], s51 offen nt lds
  v_and_b32 v2, 31, v1
  v_lshrrev_b32 v3, 5, v1
  v_lshlrev_b32 v12, 8, v2
  v_lshl_add_u32 v12, v3, 4, v12
  v_add_u32 v12, s46, v12
  v_bfe_u32 v13, v2, 1, 3
  v_xor_b32 v13, v13, v3
  v_lshlrev_b32 v13, 4, v13
  v_lshl_add_u32 v240, v2, 7, v13
  v_xor_b32 v241, 32, v240
  v_xor_b32 v242, 64, v240
  v_xor_b32 v243, 96, v240
  v_bfe_u32 v13, v1, 2, 2
  v_lshl_add_u32 v14, v3, 2, v13
  v_lshlrev_b32 v14, 7, v14
  v_lshrrev_b32 v13, 1, v13
  v_lshl_add_u32 v14, v13, 6, v14
  v_bfe_u32 v13, v1, 4, 1
  v_xor_b32 v13, v13, v3
  v_lshl_add_u32 v14, v13, 5, v14
  v_and_b32 v13, 3, v1
  v_lshl_add_u32 v14, v13, 3, v14
  v_add_u32 v244, 0x10000, v14
  v_xor_b32 v245, 64, v244
  v_mov_b32 v8, v244
  v_mov_b32 v9, v245
  v_add_u32 v4, s48, v240
  v_add_u32 v5, s48, v241
  v_add_u32 v6, s48, v242
  v_add_u32 v7, s48, v243
  v_mov_b32 v10, 0
  v_mov_b32 v11, 0
  v_and_b32 v13, 3, v1
  v_bfe_u32 v14, v1, 4, 1
  v_cmp_eq_u32 vcc, v13, v14
  v_mov_b32 v13, 0x3f803f80
  s_nop 1
  v_cndmask_b32 v248, 0, v13, vcc
  v_mov_b32 v252, 0
  v_cndmask_b32 v249, 0, v13, vcc
  v_mov_b32 v253, 0
  v_cndmask_b32 v250, 0, v13, vcc
  v_mov_b32 v254, 0
  v_cndmask_b32 v251, 0, v13, vcc
  v_mov_b32 v255, 0
  v_mov_b32 v176, 0
  v_mov_b32 v177, 0
  v_mov_b32 v178, 0
  v_mov_b32 v179, 0
  v_mov_b32 v180, 0
  v_mov_b32 v181, 0
  v_mov_b32 v182, 0
  v_mov_b32 v183, 0
  v_mov_b32 v184, 0
  v_mov_b32 v185, 0
  v_mov_b32 v186, 0
  v_mov_b32 v187, 0
  v_mov_b32 v188, 0
  v_mov_b32 v189, 0
  v_mov_b32 v190, 0
  v_mov_b32 v191, 0
  v_mov_b32 v192, 0
  v_mov_b32 v193, 0
  v_mov_b32 v194, 0
  v_mov_b32 v195, 0
  v_mov_b32 v196, 0
  v_mov_b32 v197, 0
  v_mov_b32 v198, 0
  v_mov_b32 v199, 0
  v_mov_b32 v200, 0
  v_mov_b32 v201, 0
  v_mov_b32 v202, 0
  v_mov_b32 v203, 0
  v_mov_b32 v204, 0
  v_mov_b32 v205, 0
  v_mov_b32 v206, 0
  v_mov_b32 v207, 0
  v_mov_b32 v208, 0
  v_mov_b32 v209, 0
  v_mov_b32 v210, 0
  v_mov_b32 v211, 0
  v_mov_b32 v212, 0
  v_mov_b32 v213, 0
  v_mov_b32 v214, 0
  v_mov_b32 v215, 0
  v_mov_b32 v216, 0
  v_mov_b32 v217, 0
  v_mov_b32 v218, 0
  v_mov_b32 v219, 0
  v_mov_b32 v220, 0
  v_mov_b32 v221, 0
  v_mov_b32 v222, 0
  v_mov_b32 v223, 0
  v_mov_b32 v224, 0
  v_mov_b32 v225, 0
  v_mov_b32 v226, 0
  v_mov_b32 v227, 0
  v_mov_b32 v228, 0
  v_mov_b32 v229, 0
  v_mov_b32 v230, 0
  v_mov_b32 v231, 0
  v_mov_b32 v232, 0
  v_mov_b32 v233, 0
  v_mov_b32 v234, 0
  v_mov_b32 v235, 0
  v_mov_b32 v236, 0
  v_mov_b32 v237, 0
  v_mov_b32 v238, 0
  v_mov_b32 v239, 0
  s_mov_b32 s39, 1
  s_mov_b32 s40, 0
  s_mov_b32 s38, 0xfffffff1
  s_waitcnt vmcnt(4)
  ds_read_b128 v[16:19], v4 offset:0
  ds_read_b128 v[20:23], v5 offset:0
  ds_read_b128 v[24:27], v6 offset:0
  ds_read_b128 v[28:31], v7 offset:0
  s_waitcnt lgkmcnt(3)
  v_lshlrev_b32 v13, 16, v16
  v_and_b32 v14, 0xffff0000, v16
  v_lshlrev_b32 v15, 16, v17
  v_and_b32 v2, 0xffff0000, v17
  v_mul_f32 v13, s37, v13
  v_mul_f32 v14, s37, v14
  v_mul_f32 v15, s37, v15
  v_mul_f32 v2, s37, v2
  v_cvt_pk_bf16_f32 v16, v13, v14
  v_cvt_pk_bf16_f32 v17, v15, v2
  v_lshlrev_b32 v13, 16, v18
  v_and_b32 v14, 0xffff0000, v18
  v_lshlrev_b32 v15, 16, v19
  v_and_b32 v2, 0xffff0000, v19
  v_mul_f32 v13, s37, v13
  v_mul_f32 v14, s37, v14
  v_mul_f32 v15, s37, v15
  v_mul_f32 v2, s37, v2
  v_cvt_pk_bf16_f32 v18, v13, v14
  v_cvt_pk_bf16_f32 v19, v15, v2
  s_waitcnt lgkmcnt(2)
  v_lshlrev_b32 v13, 16, v20
  v_and_b32 v14, 0xffff0000, v20
  v_lshlrev_b32 v15, 16, v21
  v_and_b32 v2, 0xffff0000, v21
  v_mul_f32 v13, s37, v13
  v_mul_f32 v14, s37, v14
  v_mul_f32 v15, s37, v15
  v_mul_f32 v2, s37, v2
  v_cvt_pk_bf16_f32 v20, v13, v14
  v_cvt_pk_bf16_f32 v21, v15, v2
  v_lshlrev_b32 v13, 16, v22
  v_and_b32 v14, 0xffff0000, v22
  v_lshlrev_b32 v15, 16, v23
  v_and_b32 v2, 0xffff0000, v23
  v_mul_f32 v13, s37, v13
  v_mul_f32 v14, s37, v14
  v_mul_f32 v15, s37, v15
  v_mul_f32 v2, s37, v2
  v_cvt_pk_bf16_f32 v22, v13, v14
  v_cvt_pk_bf16_f32 v23, v15, v2
  s_waitcnt lgkmcnt(1)
  v_lshlrev_b32 v13, 16, v24
  v_and_b32 v14, 0xffff0000, v24
  v_lshlrev_b32 v15, 16, v25
  v_and_b32 v2, 0xffff0000, v25
  v_mul_f32 v13, s37, v13
  v_mul_f32 v14, s37, v14
  v_mul_f32 v15, s37, v15
  v_mul_f32 v2, s37, v2
  v_cvt_pk_bf16_f32 v24, v13, v14
  v_cvt_pk_bf16_f32 v25, v15, v2
  v_lshlrev_b32 v13, 16, v26
  v_and_b32 v14, 0xffff0000, v26
  v_lshlrev_b32 v15, 16, v27
  v_and_b32 v2, 0xffff0000, v27
  v_mul_f32 v13, s37, v13
  v_mul_f32 v14, s37, v14
  v_mul_f32 v15, s37, v15
  v_mul_f32 v2, s37, v2
  v_cvt_pk_bf16_f32 v26, v13, v14
  v_cvt_pk_bf16_f32 v27, v15, v2
  s_waitcnt lgkmcnt(0)
  v_lshlrev_b32 v13, 16, v28
  v_and_b32 v14, 0xffff0000, v28
  v_lshlrev_b32 v15, 16, v29
  v_and_b32 v2, 0xffff0000, v29
  v_mul_f32 v13, s37, v13
  v_mul_f32 v14, s37, v14
  v_mul_f32 v15, s37, v15
  v_mul_f32 v2, s37, v2
  v_cvt_pk_bf16_f32 v28, v13, v14
  v_cvt_pk_bf16_f32 v29, v15, v2
  v_lshlrev_b32 v13, 16, v30
  v_and_b32 v14, 0xffff0000, v30
  v_lshlrev_b32 v15, 16, v31
  v_and_b32 v2, 0xffff0000, v31
  v_mul_f32 v13, s37, v13
  v_mul_f32 v14, s37, v14
  v_mul_f32 v15, s37, v15
  v_mul_f32 v2, s37, v2
  v_cvt_pk_bf16_f32 v30, v13, v14
  v_cvt_pk_bf16_f32 v31, v15, v2
  s_waitcnt vmcnt(0)
  ds_read_b128 v[32:35], v4 offset:4096
  ds_read_b128 v[36:39], v5 offset:4096
  ds_read_b128 v[40:43], v6 offset:4096
  ds_read_b128 v[44:47], v7 offset:4096
  s_waitcnt lgkmcnt(0)
  s_barrier
  ds_read_b128 v[112:115], v240 offset:0
  ds_read_b128 v[116:119], v241 offset:0
  ds_read_b128 v[120:123], v242 offset:0
  ds_read_b128 v[124:127], v243 offset:0
  ds_read_b128 v[128:131], v240 offset:4096
  ds_read_b128 v[132:135], v241 offset:4096
  ds_read_b128 v[136:139], v242 offset:4096
  ds_read_b128 v[140:143], v243 offset:4096
  v_lshlrev_b32 v13, 16, v32
  v_and_b32 v14, 0xffff0000, v32
  v_lshlrev_b32 v15, 16, v33
  v_and_b32 v2, 0xffff0000, v33
  v_mul_f32 v13, s37, v13
  v_mul_f32 v14, s37, v14
  v_mul_f32 v15, s37, v15
  v_mul_f32 v2, s37, v2
  v_cvt_pk_bf16_f32 v32, v13, v14
  v_cvt_pk_bf16_f32 v33, v15, v2
  v_lshlrev_b32 v13, 16, v34
  v_and_b32 v14, 0xffff0000, v34
  v_lshlrev_b32 v15, 16, v35
  v_and_b32 v2, 0xffff0000, v35
  v_mul_f32 v13, s37, v13
  v_mul_f32 v14, s37, v14
  v_mul_f32 v15, s37, v15
  v_mul_f32 v2, s37, v2
  v_cvt_pk_bf16_f32 v34, v13, v14
  v_cvt_pk_bf16_f32 v35, v15, v2
  s_waitcnt lgkmcnt(7)
  v_mfma_f32_32x32x16_bf16 v[64:79], v[112:115], v[16:19], 0
  v_lshlrev_b32 v13, 16, v36
  v_and_b32 v14, 0xffff0000, v36
  v_lshlrev_b32 v15, 16, v37
  v_and_b32 v2, 0xffff0000, v37
  v_mul_f32 v13, s37, v13
  v_mul_f32 v14, s37, v14
  v_mul_f32 v15, s37, v15
  v_mul_f32 v2, s37, v2
  v_cvt_pk_bf16_f32 v36, v13, v14
  v_cvt_pk_bf16_f32 v37, v15, v2
  v_lshlrev_b32 v13, 16, v38
  v_and_b32 v14, 0xffff0000, v38
  v_lshlrev_b32 v15, 16, v39
  v_and_b32 v2, 0xffff0000, v39
  v_mul_f32 v13, s37, v13
  v_mul_f32 v14, s37, v14
  v_mul_f32 v15, s37, v15
  v_mul_f32 v2, s37, v2
  v_cvt_pk_bf16_f32 v38, v13, v14
  v_cvt_pk_bf16_f32 v39, v15, v2
  s_nop 1
  s_waitcnt lgkmcnt(6)
  v_mfma_f32_32x32x16_bf16 v[64:79], v[116:119], v[20:23], v[64:79]
  v_lshlrev_b32 v13, 16, v40
  v_and_b32 v14, 0xffff0000, v40
  v_lshlrev_b32 v15, 16, v41
  v_and_b32 v2, 0xffff0000, v41
  v_mul_f32 v13, s37, v13
  v_mul_f32 v14, s37, v14
  v_mul_f32 v15, s37, v15
  v_mul_f32 v2, s37, v2
  v_cvt_pk_bf16_f32 v40, v13, v14
  v_cvt_pk_bf16_f32 v41, v15, v2
  v_lshlrev_b32 v13, 16, v42
  v_and_b32 v14, 0xffff0000, v42
  v_lshlrev_b32 v15, 16, v43
  v_and_b32 v2, 0xffff0000, v43
  v_mul_f32 v13, s37, v13
  v_mul_f32 v14, s37, v14
  v_mul_f32 v15, s37, v15
  v_mul_f32 v2, s37, v2
  v_cvt_pk_bf16_f32 v42, v13, v14
  v_cvt_pk_bf16_f32 v43, v15, v2
  s_nop 1
  s_waitcnt lgkmcnt(5)
  v_mfma_f32_32x32x16_bf16 v[64:79], v[120:123], v[24:27], v[64:79]
  v_lshlrev_b32 v13, 16, v44
  v_and_b32 v14, 0xffff0000, v44
  v_lshlrev_b32 v15, 16, v45
  v_and_b32 v2, 0xffff0000, v45
  v_mul_f32 v13, s37, v13
  v_mul_f32 v14, s37, v14
  v_mul_f32 v15, s37, v15
  v_mul_f32 v2, s37, v2
  v_cvt_pk_bf16_f32 v44, v13, v14
  v_cvt_pk_bf16_f32 v45, v15, v2
  v_lshlrev_b32 v13, 16, v46
  v_and_b32 v14, 0xffff0000, v46
  v_lshlrev_b32 v15, 16, v47
  v_and_b32 v2, 0xffff0000, v47
  v_mul_f32 v13, s37, v13
  v_mul_f32 v14, s37, v14
  v_mul_f32 v15, s37, v15
  v_mul_f32 v2, s37, v2
  v_cvt_pk_bf16_f32 v46, v13, v14
  v_cvt_pk_bf16_f32 v47, v15, v2
  s_nop 1
  s_waitcnt lgkmcnt(4)
  v_mfma_f32_32x32x16_bf16 v[64:79], v[124:127], v[28:31], v[64:79]
  s_waitcnt lgkmcnt(3)
  v_mfma_f32_32x32x16_bf16 v[64:79], v[128:131], v[32:35], v[64:79]
  s_waitcnt lgkmcnt(2)
  v_mfma_f32_32x32x16_bf16 v[64:79], v[132:135], v[36:39], v[64:79]
  s_waitcnt lgkmcnt(1)
  v_mfma_f32_32x32x16_bf16 v[64:79], v[136:139], v[40:43], v[64:79]
  s_waitcnt lgkmcnt(0)
  v_mfma_f32_32x32x16_bf16 v[64:79], v[140:143], v[44:47], v[64:79]
  s_barrier
  ds_read_b128 v[112:115], v240 offset:8192
  ds_read_b128 v[116:119], v241 offset:8192
  ds_read_b128 v[120:123], v242 offset:8192
  ds_read_b128 v[124:127], v243 offset:8192
  ds_read_b128 v[128:131], v240 offset:12288
  ds_read_b128 v[132:135], v241 offset:12288
  ds_read_b128 v[136:139], v242 offset:12288
  ds_read_b128 v[140:143], v243 offset:12288
  ds_read_b64_tr_b16 v[144:145], v8 offset:0
  ds_read_b64_tr_b16 v[146:147], v8 offset:1024
  ds_read_b64_tr_b16 v[148:149], v9 offset:0
  ds_read_b64_tr_b16 v[150:151], v9 offset:1024
  ds_read_b64_tr_b16 v[152:153], v8 offset:4096
  ds_read_b64_tr_b16 v[154:155], v8 offset:5120
  ds_read_b64_tr_b16 v[156:157], v9 offset:4096
  v_add_u32 v4, 0x4000, v240
  v_add_u32 v5, 0x4000, v241
  v_add_u32 v6, 0x4000, v242
  v_add_u32 v7, 0x4000, v243
  v_max3_f32 v13, v64, v65, v66
  v_max3_f32 v14, v67, v68, v69
  v_max3_f32 v13, v13, v70, v71
  v_max3_f32 v14, v14, v72, v73
  v_max3_f32 v13, v13, v74, v75
  v_max3_f32 v14, v14, v76, v77
  v_max3_f32 v13, v13, v78, v79
  v_max_f32 v13, v13, v14
  v_mov_b32 v14, v13
  s_nop 1
  v_permlane32_swap_b32 v13, v14
  v_max_f32 v13, v13, v14
  v_sub_f32 v64, v64, v13
  v_sub_f32 v65, v65, v13
  v_sub_f32 v66, v66, v13
  v_sub_f32 v67, v67, v13
  v_sub_f32 v68, v68, v13
  v_sub_f32 v69, v69, v13
  v_sub_f32 v70, v70, v13
  v_sub_f32 v71, v71, v13
  v_sub_f32 v72, v72, v13
  v_sub_f32 v73, v73, v13
  v_sub_f32 v74, v74, v13
  v_sub_f32 v75, v75, v13
  v_sub_f32 v76, v76, v13
  v_sub_f32 v77, v77, v13
  v_sub_f32 v78, v78, v13
  v_sub_f32 v79, v79, v13
  v_sub_f32 v48, 0, v13
  v_sub_f32 v49, 0, v13
  v_sub_f32 v50, 0, v13
  v_sub_f32 v51, 0, v13
  v_sub_f32 v52, 0, v13
  v_sub_f32 v53, 0, v13
  v_sub_f32 v54, 0, v13
  v_sub_f32 v55, 0, v13
  v_sub_f32 v56, 0, v13
  v_sub_f32 v57, 0, v13
  v_sub_f32 v58, 0, v13
  v_sub_f32 v59, 0, v13
  v_sub_f32 v60, 0, v13
  v_sub_f32 v61, 0, v13
  v_sub_f32 v62, 0, v13
  v_sub_f32 v63, 0, v13
  v_exp_f32 v64, v64
  s_nop 0
  v_exp_f32 v65, v65
  v_exp_f32 v66, v66
  v_cvt_pk_bf16_f32 v96, v64, v65
  v_exp_f32 v67, v67
  v_exp_f32 v68, v68
  v_cvt_pk_bf16_f32 v97, v66, v67
  v_exp_f32 v69, v69
  s_waitcnt lgkmcnt(0)
.p2align 6
L_main_loop0:
  v_mfma_f32_32x32x16_bf16 v[80:95], v[112:115], v[16:19], v[48:63]
  ds_read_b64_tr_b16 v[158:159], v9 offset:5120
  v_exp_f32 v70, v70
  v_cvt_pk_bf16_f32 v98, v68, v69
  s_barrier
  v_mfma_f32_32x32x16_bf16 v[80:95], v[116:119], v[20:23], v[80:95]
  ds_read_b64_tr_b16 v[160:161], v8 offset:2048
  ds_read_b128 v[112:115], v4 offset:0
  v_exp_f32 v71, v71
  v_mfma_f32_32x32x16_bf16 v[80:95], v[120:123], v[24:27], v[80:95]
  ds_read_b64_tr_b16 v[162:163], v8 offset:3072
  v_exp_f32 v72, v72
  v_cvt_pk_bf16_f32 v99, v70, v71
  v_lshl_add_u32 v7, s39, 14, v243
  v_mfma_f32_32x32x16_bf16 v[80:95], v[124:127], v[28:31], v[80:95]
  ds_read_b64_tr_b16 v[164:165], v9 offset:2048
  ds_read_b128 v[116:119], v5 offset:0
  v_exp_f32 v73, v73
  s_waitcnt lgkmcnt(12)
  v_mfma_f32_32x32x16_bf16 v[80:95], v[128:131], v[32:35], v[80:95]
  ds_read_b64_tr_b16 v[166:167], v9 offset:3072
  v_exp_f32 v74, v74
  v_cvt_pk_bf16_f32 v100, v72, v73
  v_mfma_f32_16x16x32_bf16 v[252:255], v[248:251], v[96:99], v[252:255]
  v_mfma_f32_32x32x16_bf16 v[80:95], v[132:135], v[36:39], v[80:95]
  ds_read_b64_tr_b16 v[168:169], v8 offset:6144
  ds_read_b128 v[120:123], v6 offset:0
  v_exp_f32 v75, v75
  s_waitcnt lgkmcnt(9)
  v_mfma_f32_32x32x16_bf16 v[80:95], v[136:139], v[40:43], v[80:95]
  ds_read_b64_tr_b16 v[170:171], v8 offset:7168
  v_exp_f32 v76, v76
  v_cvt_pk_bf16_f32 v101, v74, v75
  v_mfma_f32_32x32x16_bf16 v[80:95], v[140:143], v[44:47], v[80:95]
  ds_read_b64_tr_b16 v[172:173], v9 offset:6144
  ds_read_b128 v[124:127], v7 offset:0
  v_exp_f32 v77, v77
  v_mfma_f32_32x32x16_bf16 v[176:191], v[144:147], v[96:99], v[176:191]
  ds_read_b64_tr_b16 v[174:175], v9 offset:7168
  v_exp_f32 v78, v78
  v_cvt_pk_bf16_f32 v102, v76, v77
  v_mfma_f32_32x32x16_bf16 v[192:207], v[148:151], v[96:99], v[192:207]
  ds_read_b64_tr_b16 v[144:145], v8 offset:8192
  ds_read_b128 v[128:131], v4 offset:4096
  v_exp_f32 v79, v79
  s_waitcnt lgkmcnt(14)
  v_mfma_f32_32x32x16_bf16 v[208:223], v[152:155], v[96:99], v[208:223]
  ds_read_b64_tr_b16 v[146:147], v8 offset:9216
  v_exp_f32 v80, v80
  v_cvt_pk_bf16_f32 v103, v78, v79
  v_mfma_f32_32x32x16_bf16 v[224:239], v[156:159], v[96:99], v[224:239]
  ds_read_b64_tr_b16 v[148:149], v9 offset:8192
  ds_read_b128 v[132:135], v5 offset:4096
  v_exp_f32 v81, v81
  s_waitcnt lgkmcnt(11)
  v_mfma_f32_32x32x16_bf16 v[176:191], v[160:163], v[100:103], v[176:191]
  ds_read_b64_tr_b16 v[150:151], v9 offset:9216
  v_exp_f32 v82, v82
  v_cvt_pk_bf16_f32 v104, v80, v81
  v_mfma_f32_16x16x32_bf16 v[252:255], v[248:251], v[100:103], v[252:255]
  v_mfma_f32_32x32x16_bf16 v[192:207], v[164:167], v[100:103], v[192:207]
  ds_read_b64_tr_b16 v[152:153], v8 offset:12288
  ds_read_b128 v[136:139], v6 offset:4096
  v_exp_f32 v83, v83
  s_waitcnt lgkmcnt(8)
  v_mfma_f32_32x32x16_bf16 v[208:223], v[168:171], v[100:103], v[208:223]
  ds_read_b64_tr_b16 v[154:155], v8 offset:13312
  v_exp_f32 v84, v84
  v_cvt_pk_bf16_f32 v105, v82, v83
  v_mfma_f32_32x32x16_bf16 v[224:239], v[172:175], v[100:103], v[224:239]
  ds_read_b64_tr_b16 v[156:157], v9 offset:12288
  ds_read_b128 v[140:143], v7 offset:4096
  v_exp_f32 v85, v85
  v_mfma_f32_32x32x16_bf16 v[64:79], v[112:115], v[16:19], v[48:63]
  ds_read_b64_tr_b16 v[158:159], v9 offset:13312
  v_exp_f32 v86, v86
  v_cvt_pk_bf16_f32 v106, v84, v85
  s_barrier
  v_mfma_f32_32x32x16_bf16 v[64:79], v[116:119], v[20:23], v[64:79]
  ds_read_b64_tr_b16 v[160:161], v8 offset:10240
  ds_read_b128 v[112:115], v4 offset:8192
  v_exp_f32 v87, v87
  v_mfma_f32_32x32x16_bf16 v[64:79], v[120:123], v[24:27], v[64:79]
  ds_read_b64_tr_b16 v[162:163], v8 offset:11264
  v_exp_f32 v88, v88
  v_cvt_pk_bf16_f32 v107, v86, v87
  s_add_u32 s38, s38, 1
  v_mfma_f32_32x32x16_bf16 v[64:79], v[124:127], v[28:31], v[64:79]
  ds_read_b64_tr_b16 v[164:165], v9 offset:10240
  ds_read_b128 v[116:119], v5 offset:8192
  v_exp_f32 v89, v89
  s_waitcnt lgkmcnt(12)
  v_mfma_f32_32x32x16_bf16 v[64:79], v[128:131], v[32:35], v[64:79]
  ds_read_b64_tr_b16 v[166:167], v9 offset:11264
  v_exp_f32 v90, v90
  v_cvt_pk_bf16_f32 v108, v88, v89
  v_mfma_f32_16x16x32_bf16 v[252:255], v[248:251], v[104:107], v[252:255]
  v_mfma_f32_32x32x16_bf16 v[64:79], v[132:135], v[36:39], v[64:79]
  ds_read_b64_tr_b16 v[168:169], v8 offset:14336
  ds_read_b128 v[120:123], v6 offset:8192
  v_exp_f32 v91, v91
  s_waitcnt lgkmcnt(9)
  v_mfma_f32_32x32x16_bf16 v[64:79], v[136:139], v[40:43], v[64:79]
  ds_read_b64_tr_b16 v[170:171], v8 offset:15360
  v_exp_f32 v92, v92
  v_cvt_pk_bf16_f32 v109, v90, v91
  v_lshl_add_u32 v8, s39, 14, v244
  v_mfma_f32_32x32x16_bf16 v[64:79], v[140:143], v[44:47], v[64:79]
  ds_read_b64_tr_b16 v[172:173], v9 offset:14336
  ds_read_b128 v[124:127], v7 offset:8192
  v_exp_f32 v93, v93
  v_mfma_f32_32x32x16_bf16 v[176:191], v[144:147], v[104:107], v[176:191]
  ds_read_b64_tr_b16 v[174:175], v9 offset:15360
  v_exp_f32 v94, v94
  v_cvt_pk_bf16_f32 v110, v92, v93
  v_lshl_add_u32 v9, s39, 14, v245
  s_add_u32 s39, s39, 1
  v_mfma_f32_32x32x16_bf16 v[192:207], v[148:151], v[104:107], v[192:207]
  ds_read_b64_tr_b16 v[144:145], v8 offset:0
  ds_read_b128 v[128:131], v4 offset:12288
  v_exp_f32 v95, v95
  s_and_b32 s39, s39, 3
  s_waitcnt lgkmcnt(14)
  v_mfma_f32_32x32x16_bf16 v[208:223], v[152:155], v[104:107], v[208:223]
  ds_read_b64_tr_b16 v[146:147], v8 offset:1024
  v_exp_f32 v64, v64
  v_cvt_pk_bf16_f32 v111, v94, v95
  v_lshl_add_u32 v4, s39, 14, v240
  v_mfma_f32_32x32x16_bf16 v[224:239], v[156:159], v[104:107], v[224:239]
  ds_read_b64_tr_b16 v[148:149], v9 offset:0
  ds_read_b128 v[132:135], v5 offset:12288
  v_exp_f32 v65, v65
  v_lshl_add_u32 v5, s39, 14, v241
  s_waitcnt lgkmcnt(11)
  v_mfma_f32_32x32x16_bf16 v[176:191], v[160:163], v[108:111], v[176:191]
  ds_read_b64_tr_b16 v[150:151], v9 offset:1024
  v_exp_f32 v66, v66
  v_cvt_pk_bf16_f32 v96, v64, v65
  v_mfma_f32_16x16x32_bf16 v[252:255], v[248:251], v[108:111], v[252:255]
  v_mfma_f32_32x32x16_bf16 v[192:207], v[164:167], v[108:111], v[192:207]
  ds_read_b64_tr_b16 v[152:153], v8 offset:4096
  ds_read_b128 v[136:139], v6 offset:12288
  v_exp_f32 v67, v67
  s_waitcnt lgkmcnt(8)
  v_mfma_f32_32x32x16_bf16 v[208:223], v[168:171], v[108:111], v[208:223]
  ds_read_b64_tr_b16 v[154:155], v8 offset:5120
  v_exp_f32 v68, v68
  v_cvt_pk_bf16_f32 v97, v66, v67
  v_lshl_add_u32 v6, s39, 14, v242
  s_cmp_eq_u32 s38, 0
  v_mfma_f32_32x32x16_bf16 v[224:239], v[172:175], v[108:111], v[224:239]
  ds_read_b64_tr_b16 v[156:157], v9 offset:4096
  ds_read_b128 v[140:143], v7 offset:12288
  v_exp_f32 v69, v69
  s_cbranch_scc0 L_main_loop0
  v_mfma_f32_32x32x16_bf16 v[80:95], v[112:115], v[16:19], v[48:63]
  ds_read_b64_tr_b16 v[158:159], v9 offset:5120
  v_exp_f32 v70, v70
  v_cvt_pk_bf16_f32 v98, v68, v69
  s_barrier
  v_mfma_f32_32x32x16_bf16 v[80:95], v[116:119], v[20:23], v[80:95]
  ds_read_b64_tr_b16 v[160:161], v8 offset:2048
  v_exp_f32 v71, v71
  v_mfma_f32_32x32x16_bf16 v[80:95], v[120:123], v[24:27], v[80:95]
  ds_read_b64_tr_b16 v[162:163], v8 offset:3072
  v_exp_f32 v72, v72
  v_cvt_pk_bf16_f32 v99, v70, v71
  v_mfma_f32_32x32x16_bf16 v[80:95], v[124:127], v[28:31], v[80:95]
  ds_read_b64_tr_b16 v[164:165], v9 offset:2048
  v_exp_f32 v73, v73
  s_waitcnt lgkmcnt(10)
  v_mfma_f32_32x32x16_bf16 v[80:95], v[128:131], v[32:35], v[80:95]
  ds_read_b64_tr_b16 v[166:167], v9 offset:3072
  v_exp_f32 v74, v74
  v_cvt_pk_bf16_f32 v100, v72, v73
  v_mfma_f32_16x16x32_bf16 v[252:255], v[248:251], v[96:99], v[252:255]
  v_mfma_f32_32x32x16_bf16 v[80:95], v[132:135], v[36:39], v[80:95]
  ds_read_b64_tr_b16 v[168:169], v8 offset:6144
  v_exp_f32 v75, v75
  s_waitcnt lgkmcnt(6)
  v_mfma_f32_32x32x16_bf16 v[80:95], v[136:139], v[40:43], v[80:95]
  ds_read_b64_tr_b16 v[170:171], v8 offset:7168
  v_exp_f32 v76, v76
  v_cvt_pk_bf16_f32 v101, v74, v75
  v_mfma_f32_32x32x16_bf16 v[80:95], v[140:143], v[44:47], v[80:95]
  ds_read_b64_tr_b16 v[172:173], v9 offset:6144
  v_exp_f32 v77, v77
  v_mfma_f32_32x32x16_bf16 v[176:191], v[144:147], v[96:99], v[176:191]
  ds_read_b64_tr_b16 v[174:175], v9 offset:7168
  v_exp_f32 v78, v78
  v_cvt_pk_bf16_f32 v102, v76, v77
  v_mfma_f32_32x32x16_bf16 v[192:207], v[148:151], v[96:99], v[192:207]
  ds_read_b64_tr_b16 v[144:145], v8 offset:8192
  v_exp_f32 v79, v79
  s_waitcnt lgkmcnt(9)
  v_mfma_f32_32x32x16_bf16 v[208:223], v[152:155], v[96:99], v[208:223]
  ds_read_b64_tr_b16 v[146:147], v8 offset:9216
  v_exp_f32 v80, v80
  v_cvt_pk_bf16_f32 v103, v78, v79
  v_mfma_f32_32x32x16_bf16 v[224:239], v[156:159], v[96:99], v[224:239]
  ds_read_b64_tr_b16 v[148:149], v9 offset:8192
  v_exp_f32 v81, v81
  s_waitcnt lgkmcnt(7)
  v_mfma_f32_32x32x16_bf16 v[176:191], v[160:163], v[100:103], v[176:191]
  ds_read_b64_tr_b16 v[150:151], v9 offset:9216
  v_exp_f32 v82, v82
  v_cvt_pk_bf16_f32 v104, v80, v81
  v_mfma_f32_16x16x32_bf16 v[252:255], v[248:251], v[100:103], v[252:255]
  v_mfma_f32_32x32x16_bf16 v[192:207], v[164:167], v[100:103], v[192:207]
  ds_read_b64_tr_b16 v[152:153], v8 offset:12288
  v_exp_f32 v83, v83
  s_waitcnt lgkmcnt(5)
  v_mfma_f32_32x32x16_bf16 v[208:223], v[168:171], v[100:103], v[208:223]
  ds_read_b64_tr_b16 v[154:155], v8 offset:13312
  v_exp_f32 v84, v84
  v_cvt_pk_bf16_f32 v105, v82, v83
  v_mfma_f32_32x32x16_bf16 v[224:239], v[172:175], v[100:103], v[224:239]
  ds_read_b64_tr_b16 v[156:157], v9 offset:12288
  v_exp_f32 v85, v85
L_main_last:
  ds_read_b64_tr_b16 v[158:159], v9 offset:13312
  ds_read_b64_tr_b16 v[160:161], v8 offset:10240
  ds_read_b64_tr_b16 v[162:163], v8 offset:11264
  ds_read_b64_tr_b16 v[164:165], v9 offset:10240
  ds_read_b64_tr_b16 v[166:167], v9 offset:11264
  ds_read_b64_tr_b16 v[168:169], v8 offset:14336
  ds_read_b64_tr_b16 v[170:171], v8 offset:15360
  ds_read_b64_tr_b16 v[172:173], v9 offset:14336
  ds_read_b64_tr_b16 v[174:175], v9 offset:15360
  v_and_b32 v14, 16, v1
  v_cmp_eq_u32 s[60:61], 0, v14
  v_exp_f32 v86, v86
  v_exp_f32 v87, v87
  v_cvt_pk_bf16_f32 v106, v84, v85
  v_exp_f32 v88, v88
  v_cvt_pk_bf16_f32 v107, v86, v87
  s_nop 1
  v_mfma_f32_16x16x32_bf16 v[252:255], v[248:251], v[104:107], v[252:255]
  s_waitcnt lgkmcnt(14)
  v_mfma_f32_32x32x16_bf16 v[176:191], v[144:147], v[104:107], v[176:191]
  v_exp_f32 v89, v89
  v_exp_f32 v90, v90
  v_cvt_pk_bf16_f32 v108, v88, v89
  s_waitcnt lgkmcnt(12)
  v_mfma_f32_32x32x16_bf16 v[192:207], v[148:151], v[104:107], v[192:207]
  v_exp_f32 v91, v91
  v_exp_f32 v92, v92
  v_cvt_pk_bf16_f32 v109, v90, v91
  s_waitcnt lgkmcnt(10)
  v_mfma_f32_32x32x16_bf16 v[208:223], v[152:155], v[104:107], v[208:223]
  v_exp_f32 v93, v93
  v_exp_f32 v94, v94
  v_cvt_pk_bf16_f32 v110, v92, v93
  s_waitcnt lgkmcnt(8)
  v_mfma_f32_32x32x16_bf16 v[224:239], v[156:159], v[104:107], v[224:239]
  v_exp_f32 v95, v95
  s_nop 0
  v_cvt_pk_bf16_f32 v111, v94, v95
  s_lshl_b32 s58, s3, 5
  s_lshl_b32 s59, s3, 13
  v_mfma_f32_16x16x32_bf16 v[252:255], v[248:251], v[108:111], v[252:255]
  s_waitcnt lgkmcnt(6)
  v_mfma_f32_32x32x16_bf16 v[176:191], v[160:163], v[108:111], v[176:191]
  s_waitcnt lgkmcnt(4)
  v_mfma_f32_32x32x16_bf16 v[192:207], v[164:167], v[108:111], v[192:207]
  s_mov_b64 s[56:57], -1
  s_nop 3
  v_cndmask_b32 v13, v253, v252, s[60:61]
  v_cmp_nlt_f32 vcc, v13, s49
  v_rcp_f32 v15, v13
  s_waitcnt lgkmcnt(2)
  v_mfma_f32_32x32x16_bf16 v[208:223], v[168:171], v[108:111], v[208:223]
  s_waitcnt lgkmcnt(0)
  v_mfma_f32_32x32x16_bf16 v[224:239], v[172:175], v[108:111], v[224:239]
  s_cbranch_vccnz L_slow
  v_and_b32 v2, 31, v1
  v_lshrrev_b32 v3, 5, v1
  v_and_b32 v13, 15, v1
  v_xor_b32 v3, v3, v13
  v_lshlrev_b32 v3, 4, v3
  v_lshl_add_u32 v3, v2, 8, v3
  v_add_u32 v3, s59, v3
  v_lshrrev_b32 v2, 4, v1
  v_xor_b32 v13, v13, v2
  v_lshlrev_b32 v13, 4, v13
  v_lshl_add_u32 v13, v2, 8, v13
  v_add_u32 v4, s59, v13
  v_xor_b32 v5, 64, v4
  v_xor_b32 v6, 128, v4
  v_xor_b32 v7, 192, v4
  v_lshlrev_b32 v8, 4, v1
  s_lshl_b32 s46, s3, 13
  s_add_u32 s46, s46, s35
  s_add_u32 s47, s46, 4096
  v_mul_f32 v176, v176, v15
  v_mul_f32 v177, v177, v15
  v_mul_f32 v178, v178, v15
  v_mul_f32 v179, v179, v15
  v_mul_f32 v180, v180, v15
  v_mul_f32 v181, v181, v15
  v_mul_f32 v182, v182, v15
  v_mul_f32 v183, v183, v15
  v_cvt_pk_bf16_f32 v112, v176, v177
  v_cvt_pk_bf16_f32 v113, v178, v179
  v_cvt_pk_bf16_f32 v114, v180, v181
  v_cvt_pk_bf16_f32 v115, v182, v183
  v_xor_b32 v14, 0, v3
  s_nop 0
  v_permlane32_swap_b32 v112, v114
  v_permlane32_swap_b32 v113, v115
  ds_write_b128 v14, v[112:115]
  v_mul_f32 v184, v184, v15
  v_mul_f32 v185, v185, v15
  v_mul_f32 v186, v186, v15
  v_mul_f32 v187, v187, v15
  v_mul_f32 v188, v188, v15
  v_mul_f32 v189, v189, v15
  v_mul_f32 v190, v190, v15
  v_mul_f32 v191, v191, v15
  v_cvt_pk_bf16_f32 v116, v184, v185
  v_cvt_pk_bf16_f32 v117, v186, v187
  v_cvt_pk_bf16_f32 v118, v188, v189
  v_cvt_pk_bf16_f32 v119, v190, v191
  v_xor_b32 v14, 32, v3
  s_nop 0
  v_permlane32_swap_b32 v116, v118
  v_permlane32_swap_b32 v117, v119
  ds_write_b128 v14, v[116:119]
  v_mul_f32 v192, v192, v15
  v_mul_f32 v193, v193, v15
  v_mul_f32 v194, v194, v15
  v_mul_f32 v195, v195, v15
  v_mul_f32 v196, v196, v15
  v_mul_f32 v197, v197, v15
  v_mul_f32 v198, v198, v15
  v_mul_f32 v199, v199, v15
  v_cvt_pk_bf16_f32 v120, v192, v193
  v_cvt_pk_bf16_f32 v121, v194, v195
  v_cvt_pk_bf16_f32 v122, v196, v197
  v_cvt_pk_bf16_f32 v123, v198, v199
  v_xor_b32 v14, 64, v3
  s_nop 0
  v_permlane32_swap_b32 v120, v122
  v_permlane32_swap_b32 v121, v123
  ds_write_b128 v14, v[120:123]
  v_mul_f32 v200, v200, v15
  v_mul_f32 v201, v201, v15
  v_mul_f32 v202, v202, v15
  v_mul_f32 v203, v203, v15
  v_mul_f32 v204, v204, v15
  v_mul_f32 v205, v205, v15
  v_mul_f32 v206, v206, v15
  v_mul_f32 v207, v207, v15
  v_cvt_pk_bf16_f32 v124, v200, v201
  v_cvt_pk_bf16_f32 v125, v202, v203
  v_cvt_pk_bf16_f32 v126, v204, v205
  v_cvt_pk_bf16_f32 v127, v206, v207
  v_xor_b32 v14, 96, v3
  s_nop 0
  v_permlane32_swap_b32 v124, v126
  v_permlane32_swap_b32 v125, v127
  ds_write_b128 v14, v[124:127]
  v_mul_f32 v208, v208, v15
  v_mul_f32 v209, v209, v15
  v_mul_f32 v210, v210, v15
  v_mul_f32 v211, v211, v15
  v_mul_f32 v212, v212, v15
  v_mul_f32 v213, v213, v15
  v_mul_f32 v214, v214, v15
  v_mul_f32 v215, v215, v15
  v_cvt_pk_bf16_f32 v128, v208, v209
  v_cvt_pk_bf16_f32 v129, v210, v211
  v_cvt_pk_bf16_f32 v130, v212, v213
  v_cvt_pk_bf16_f32 v131, v214, v215
  v_xor_b32 v14, 128, v3
  s_nop 0
  v_permlane32_swap_b32 v128, v130
  v_permlane32_swap_b32 v129, v131
  ds_write_b128 v14, v[128:131]
  v_mul_f32 v216, v216, v15
  v_mul_f32 v217, v217, v15
  v_mul_f32 v218, v218, v15
  v_mul_f32 v219, v219, v15
  v_mul_f32 v220, v220, v15
  v_mul_f32 v221, v221, v15
  v_mul_f32 v222, v222, v15
  v_mul_f32 v223, v223, v15
  v_cvt_pk_bf16_f32 v132, v216, v217
  v_cvt_pk_bf16_f32 v133, v218, v219
  v_cvt_pk_bf16_f32 v134, v220, v221
  v_cvt_pk_bf16_f32 v135, v222, v223
  v_xor_b32 v14, 160, v3
  s_nop 0
  v_permlane32_swap_b32 v132, v134
  v_permlane32_swap_b32 v133, v135
  ds_write_b128 v14, v[132:135]
  v_mul_f32 v224, v224, v15
  v_mul_f32 v225, v225, v15
  v_mul_f32 v226, v226, v15
  v_mul_f32 v227, v227, v15
  v_mul_f32 v228, v228, v15
  v_mul_f32 v229, v229, v15
  v_mul_f32 v230, v230, v15
  v_mul_f32 v231, v231, v15
  v_cvt_pk_bf16_f32 v136, v224, v225
  v_cvt_pk_bf16_f32 v137, v226, v227
  v_cvt_pk_bf16_f32 v138, v228, v229
  v_cvt_pk_bf16_f32 v139, v230, v231
  v_xor_b32 v14, 192, v3
  s_nop 0
  v_permlane32_swap_b32 v136, v138
  v_permlane32_swap_b32 v137, v139
  ds_write_b128 v14, v[136:139]
  v_mul_f32 v232, v232, v15
  v_mul_f32 v233, v233, v15
  v_mul_f32 v234, v234, v15
  v_mul_f32 v235, v235, v15
  v_mul_f32 v236, v236, v15
  v_mul_f32 v237, v237, v15
  v_mul_f32 v238, v238, v15
  v_mul_f32 v239, v239, v15
  v_cvt_pk_bf16_f32 v140, v232, v233
  v_cvt_pk_bf16_f32 v141, v234, v235
  v_cvt_pk_bf16_f32 v142, v236, v237
  v_cvt_pk_bf16_f32 v143, v238, v239
  v_xor_b32 v14, 224, v3
  s_nop 0
  v_permlane32_swap_b32 v140, v142
  v_permlane32_swap_b32 v141, v143
  ds_write_b128 v14, v[140:143]
  s_waitcnt lgkmcnt(0)
  ds_read_b128 v[144:147], v4 offset:0
  ds_read_b128 v[148:151], v5 offset:1024
  ds_read_b128 v[152:155], v6 offset:2048
  ds_read_b128 v[156:159], v7 offset:3072
  ds_read_b128 v[160:163], v4 offset:4096
  ds_read_b128 v[164:167], v5 offset:5120
  ds_read_b128 v[168:171], v6 offset:6144
  ds_read_b128 v[172:175], v7 offset:7168
  s_waitcnt lgkmcnt(7)
  buffer_store_dwordx4 v[144:147], v8, s[20:23], s46 offen offset:0 nt
  s_waitcnt lgkmcnt(6)
  buffer_store_dwordx4 v[148:151], v8, s[20:23], s46 offen offset:1024 nt
  s_waitcnt lgkmcnt(5)
  buffer_store_dwordx4 v[152:155], v8, s[20:23], s46 offen offset:2048 nt
  s_waitcnt lgkmcnt(4)
  buffer_store_dwordx4 v[156:159], v8, s[20:23], s46 offen offset:3072 nt
  s_waitcnt lgkmcnt(3)
  buffer_store_dwordx4 v[160:163], v8, s[20:23], s47 offen offset:0 nt
  s_waitcnt lgkmcnt(2)
  buffer_store_dwordx4 v[164:167], v8, s[20:23], s47 offen offset:1024 nt
  s_waitcnt lgkmcnt(1)
  buffer_store_dwordx4 v[168:171], v8, s[20:23], s47 offen offset:2048 nt
  s_waitcnt lgkmcnt(0)
  buffer_store_dwordx4 v[172:175], v8, s[20:23], s47 offen offset:3072 nt
  s_endpgm
L_helper:
  s_setprio 2
  s_sub_u32 s42, s3, 4
  s_lshr_b32 s46, s42, 1
  s_and_b32 s47, s42, 1
  s_lshl_b32 s48, s46, 13
  s_lshl_b32 s51, s47, 11
  s_add_u32 s48, s48, s51
  s_add_u32 s56, s48, 0xc000
  s_add_u32 s48, s35, 0x8000
  s_add_u32 m0, s56, 0
  s_add_u32 s51, s48, 0
  buffer_load_dwordx4 v14, s[8:11], s51 offen nt lds
  s_add_u32 m0, s56, 1024
  s_add_u32 s51, s48, 2048
  buffer_load_dwordx4 v15, s[8:11], s51 offen nt lds
  s_add_u32 m0, s56, 4096
  s_add_u32 s51, s48, 128
  buffer_load_dwordx4 v14, s[8:11], s51 offen nt lds
  s_add_u32 m0, s56, 5120
  s_add_u32 s51, s48, 2176
  buffer_load_dwordx4 v15, s[8:11], s51 offen nt lds
  s_cmp_eq_u32 s46, 1
  s_cselect_b32 s24, s16, s12
  s_cselect_b32 s25, s17, s13
  s_cbranch_scc1 L_h_vpat
  v_mov_b32 v4, v14
  v_add_u32 v5, 1024, v15
  s_branch L_h_patdone
L_h_vpat:
  v_bfe_u32 v2, v1, 4, 1
  v_lshlrev_b32 v2, 2, v2
  v_lshrrev_b32 v3, 5, v1
  v_lshl_add_u32 v2, v3, 1, v2
  v_and_b32 v3, 7, v1
  v_xor_b32 v2, v2, v3
  v_lshlrev_b32 v2, 4, v2
  v_lshrrev_b32 v3, 3, v1
  v_lshl_add_u32 v4, v3, 8, v2
  v_add_u32 v5, 1024, v4
L_h_patdone:
  v_add_u32 v243, 2048, v4
  v_add_u32 v244, 2048, v5
  s_add_u32 s24, s24, s36
  s_addc_u32 s25, s25, 0
  s_mov_b32 s26, 262144
  s_mov_b32 s27, 0x20000
  s_sub_u32 s44, 1, s46
  s_lshl_b32 s43, s46, 16
  s_lshl_b32 s46, s47, 12
  s_add_u32 s43, s43, s46
  s_lshl_b32 s52, s47, 7
  s_mov_b32 s45, 0
  s_mov_b32 s53, 0x20800
  s_lshl_b32 s54, s33, 13
  s_lshl_b32 s51, s44, 13
L_h_init:
  s_and_b32 s46, s45, 0xffff
  s_add_u32 s46, s46, s43
  s_cmp_lt_u32 s45, 0x40000
  s_cselect_b32 m0, s46, s53
  s_add_u32 s47, s45, s52
  buffer_load_dwordx4 v4, s[24:27], s47 offen offset:0 nt lds
  buffer_load_dwordx4 v5, s[24:27], s47 offen offset:1024 nt lds
  buffer_load_dwordx4 v243, s[24:27], s47 offen offset:2048 nt lds
  buffer_load_dwordx4 v244, s[24:27], s47 offen offset:3072 nt lds
  s_add_u32 s45, s45, 0x2000
  s_cmp_le_u32 s45, s51
  s_cbranch_scc1 L_h_init
  v_and_b32 v2, 15, v1
  v_lshrrev_b32 v3, 4, v1
  v_lshrrev_b32 v13, 1, v2
  v_xor_b32 v13, v13, v3
  v_lshlrev_b32 v13, 4, v13
  v_lshl_add_u32 v6, v2, 7, v13
  v_xor_b32 v7, 64, v6
  v_bfe_u32 v13, v1, 2, 2
  v_lshl_add_u32 v14, v3, 2, v13
  v_lshlrev_b32 v14, 7, v14
  v_lshrrev_b32 v13, 1, v13
  v_lshl_add_u32 v14, v13, 6, v14
  v_and_b32 v13, 3, v1
  v_lshl_add_u32 v14, v13, 3, v14
  v_and_b32 v13, 1, v3
  v_lshl_add_u32 v14, v13, 5, v14
  v_add_u32 v8, 0x10000, v14
  v_mov_b32 v10, 0
  v_mov_b32 v112, 0
  v_mov_b32 v113, 0
  v_mov_b32 v114, 0
  v_mov_b32 v115, 0
  v_mov_b32 v116, 0
  v_mov_b32 v117, 0
  v_mov_b32 v118, 0
  v_mov_b32 v119, 0
  v_mov_b32 v120, 0
  v_mov_b32 v121, 0
  v_mov_b32 v122, 0
  v_mov_b32 v123, 0
  v_mov_b32 v124, 0
  v_mov_b32 v125, 0
  v_mov_b32 v126, 0
  v_mov_b32 v127, 0
  v_mov_b32 v128, 0
  v_mov_b32 v129, 0
  v_mov_b32 v130, 0
  v_mov_b32 v131, 0
  v_mov_b32 v132, 0
  v_mov_b32 v133, 0
  v_mov_b32 v134, 0
  v_mov_b32 v135, 0
  v_mov_b32 v136, 0
  v_mov_b32 v137, 0
  v_mov_b32 v138, 0
  v_mov_b32 v139, 0
  v_mov_b32 v140, 0
  v_mov_b32 v141, 0
  v_mov_b32 v142, 0
  v_mov_b32 v143, 0
  v_mov_b32 v13, 0x20400
  v_mov_b32 v14, 0
  ds_write_b32 v13, v14
  s_lshl_b32 s55, s42, 13
  v_add_u32 v11, s56, v6
  v_add_u32 v12, s56, v7
  s_cmp_eq_u32 s44, 1
  s_cbranch_scc1 L_h_q9k
  s_waitcnt vmcnt(4)
L_h_q9k:
  s_waitcnt vmcnt(8)
  ds_read_b128 v[16:19], v11 offset:0
  ds_read_b128 v[20:23], v12 offset:0
  ds_read_b128 v[24:27], v11 offset:4096
  ds_read_b128 v[28:31], v12 offset:4096
  s_waitcnt lgkmcnt(0)
  s_setprio 0
  v_lshlrev_b32 v13, 16, v16
  v_and_b32 v14, 0xffff0000, v16
  v_lshlrev_b32 v15, 16, v17
  v_and_b32 v242, 0xffff0000, v17
  v_mul_f32 v13, s37, v13
  v_mul_f32 v14, s37, v14
  v_mul_f32 v15, s37, v15
  v_mul_f32 v242, s37, v242
  v_cvt_pk_bf16_f32 v16, v13, v14
  v_cvt_pk_bf16_f32 v17, v15, v242
  v_lshlrev_b32 v13, 16, v18
  v_and_b32 v14, 0xffff0000, v18
  v_lshlrev_b32 v15, 16, v19
  v_and_b32 v242, 0xffff0000, v19
  v_mul_f32 v13, s37, v13
  v_mul_f32 v14, s37, v14
  v_mul_f32 v15, s37, v15
  v_mul_f32 v242, s37, v242
  v_cvt_pk_bf16_f32 v18, v13, v14
  v_cvt_pk_bf16_f32 v19, v15, v242
  v_lshlrev_b32 v13, 16, v20
  v_and_b32 v14, 0xffff0000, v20
  v_lshlrev_b32 v15, 16, v21
  v_and_b32 v242, 0xffff0000, v21
  v_mul_f32 v13, s37, v13
  v_mul_f32 v14, s37, v14
  v_mul_f32 v15, s37, v15
  v_mul_f32 v242, s37, v242
  v_cvt_pk_bf16_f32 v20, v13, v14
  v_cvt_pk_bf16_f32 v21, v15, v242
  v_lshlrev_b32 v13, 16, v22
  v_and_b32 v14, 0xffff0000, v22
  v_lshlrev_b32 v15, 16, v23
  v_and_b32 v242, 0xffff0000, v23
  v_mul_f32 v13, s37, v13
  v_mul_f32 v14, s37, v14
  v_mul_f32 v15, s37, v15
  v_mul_f32 v242, s37, v242
  v_cvt_pk_bf16_f32 v22, v13, v14
  v_cvt_pk_bf16_f32 v23, v15, v242
  v_lshlrev_b32 v13, 16, v24
  v_and_b32 v14, 0xffff0000, v24
  v_lshlrev_b32 v15, 16, v25
  v_and_b32 v242, 0xffff0000, v25
  v_mul_f32 v13, s37, v13
  v_mul_f32 v14, s37, v14
  v_mul_f32 v15, s37, v15
  v_mul_f32 v242, s37, v242
  v_cvt_pk_bf16_f32 v24, v13, v14
  v_cvt_pk_bf16_f32 v25, v15, v242
  v_lshlrev_b32 v13, 16, v26
  v_and_b32 v14, 0xffff0000, v26
  v_lshlrev_b32 v15, 16, v27
  v_and_b32 v242, 0xffff0000, v27
  v_mul_f32 v13, s37, v13
  v_mul_f32 v14, s37, v14
  v_mul_f32 v15, s37, v15
  v_mul_f32 v242, s37, v242
  v_cvt_pk_bf16_f32 v26, v13, v14
  v_cvt_pk_bf16_f32 v27, v15, v242
  v_lshlrev_b32 v13, 16, v28
  v_and_b32 v14, 0xffff0000, v28
  v_lshlrev_b32 v15, 16, v29
  v_and_b32 v242, 0xffff0000, v29
  v_mul_f32 v13, s37, v13
  v_mul_f32 v14, s37, v14
  v_mul_f32 v15, s37, v15
  v_mul_f32 v242, s37, v242
  v_cvt_pk_bf16_f32 v28, v13, v14
  v_cvt_pk_bf16_f32 v29, v15, v242
  v_lshlrev_b32 v13, 16, v30
  v_and_b32 v14, 0xffff0000, v30
  v_lshlrev_b32 v15, 16, v31
  v_and_b32 v242, 0xffff0000, v31
  v_mul_f32 v13, s37, v13
  v_mul_f32 v14, s37, v14
  v_mul_f32 v15, s37, v15
  v_mul_f32 v242, s37, v242
  v_cvt_pk_bf16_f32 v30, v13, v14
  v_cvt_pk_bf16_f32 v31, v15, v242
  s_setprio 2
  s_waitcnt vmcnt(4) lgkmcnt(0)
  s_barrier
  s_and_b32 s46, s45, 0xffff
  s_add_u32 s46, s46, s43
  s_cmp_lt_u32 s45, 0x40000
  s_cselect_b32 m0, s46, s53
  s_add_u32 s47, s45, s52
  buffer_load_dwordx4 v4, s[24:27], s47 offen offset:0 nt lds
  buffer_load_dwordx4 v5, s[24:27], s47 offen offset:1024 nt lds
  buffer_load_dwordx4 v243, s[24:27], s47 offen offset:2048 nt lds
  buffer_load_dwordx4 v244, s[24:27], s47 offen offset:3072 nt lds
  s_add_u32 s45, s45, 0x2000
  s_and_b32 s46, s45, 0xffff
  s_add_u32 s46, s46, s43
  s_cmp_lt_u32 s45, 0x40000
  s_cselect_b32 m0, s46, s53
  s_add_u32 s47, s45, s52
  buffer_load_dwordx4 v4, s[24:27], s47 offen offset:0 nt lds
  buffer_load_dwordx4 v5, s[24:27], s47 offen offset:1024 nt lds
  buffer_load_dwordx4 v243, s[24:27], s47 offen offset:2048 nt lds
  buffer_load_dwordx4 v244, s[24:27], s47 offen offset:3072 nt lds
  s_add_u32 s45, s45, 0x2000
  ds_read_b128 v[48:51], v6 offset:0
  ds_read_b128 v[52:55], v7 offset:0
  ds_read_b128 v[56:59], v6 offset:4096
  ds_read_b128 v[60:63], v7 offset:4096
  ds_read_b128 v[64:67], v6 offset:2048
  ds_read_b128 v[68:71], v7 offset:2048
  ds_read_b128 v[72:75], v6 offset:6144
  ds_read_b128 v[76:79], v7 offset:6144
  s_waitcnt vmcnt(8) lgkmcnt(0)
  s_barrier
  s_and_b32 s46, s45, 0xffff
  s_add_u32 s46, s46, s43
  s_cmp_lt_u32 s45, 0x40000
  s_cselect_b32 m0, s46, s53
  s_add_u32 s47, s45, s52
  buffer_load_dwordx4 v4, s[24:27], s47 offen offset:0 nt lds
  buffer_load_dwordx4 v5, s[24:27], s47 offen offset:1024 nt lds
  buffer_load_dwordx4 v243, s[24:27], s47 offen offset:2048 nt lds
  buffer_load_dwordx4 v244, s[24:27], s47 offen offset:3072 nt lds
  s_add_u32 s45, s45, 0x2000
  s_and_b32 s46, s45, 0xffff
  s_add_u32 s46, s46, s43
  s_cmp_lt_u32 s45, 0x40000
  s_cselect_b32 m0, s46, s53
  s_add_u32 s47, s45, s52
  buffer_load_dwordx4 v4, s[24:27], s47 offen offset:0 nt lds
  buffer_load_dwordx4 v5, s[24:27], s47 offen offset:1024 nt lds
  s_add_u32 s45, s45, 0x2000
  v_mfma_f32_16x16x32_bf16 v[36:39], v[48:51], v[16:19], 0
  v_mfma_f32_16x16x32_bf16 v[36:39], v[52:55], v[20:23], v[36:39]
  v_mfma_f32_16x16x32_bf16 v[36:39], v[56:59], v[24:27], v[36:39]
  v_mfma_f32_16x16x32_bf16 v[36:39], v[60:63], v[28:31], v[36:39]
  v_mfma_f32_16x16x32_bf16 v[40:43], v[64:67], v[16:19], 0
  v_mfma_f32_16x16x32_bf16 v[40:43], v[68:71], v[20:23], v[40:43]
  v_mfma_f32_16x16x32_bf16 v[40:43], v[72:75], v[24:27], v[40:43]
  v_mfma_f32_16x16x32_bf16 v[40:43], v[76:79], v[28:31], v[40:43]
  s_nop 7
  s_nop 1
  v_max3_f32 v13, v36, v37, v38
  v_max3_f32 v13, v13, v39, v40
  v_max3_f32 v13, v13, v41, v42
  v_max_f32 v13, v13, v43
  v_mov_b32 v14, v13
  s_nop 1
  v_permlane32_swap_b32 v13, v14
  v_max_f32 v13, v13, v14
  v_mov_b32 v14, v13
  s_nop 1
  v_permlane16_swap_b32 v13, v14
  v_max_f32 v13, v13, v14
  v_sub_f32 v32, 0, v13
  v_sub_f32 v33, 0, v13
  v_sub_f32 v34, 0, v13
  v_sub_f32 v35, 0, v13
  s_mov_b32 s41, 31
  s_mov_b32 s50, s42
L_h_pre:
  s_sub_u32 s50, s50, 1
  s_cbranch_scc1 L_h_go
  buffer_load_dwordx4 v243, s[24:27], s47 offen offset:2048 nt lds
  buffer_load_dwordx4 v244, s[24:27], s47 offen offset:3072 nt lds
  s_sub_u32 s41, s41, 1
  s_cmp_ge_u32 s41, 29
  s_cbranch_scc1 L_sk_1
  s_waitcnt vmcnt(20) lgkmcnt(0)
  s_barrier
L_si_1:
  s_and_b32 s46, s45, 0xffff
  s_add_u32 s46, s46, s43
  s_cmp_lt_u32 s45, 0x40000
  s_cselect_b32 m0, s46, s53
  s_add_u32 s47, s45, s52
  buffer_load_dwordx4 v4, s[24:27], s47 offen offset:0 nt lds
  buffer_load_dwordx4 v5, s[24:27], s47 offen offset:1024 nt lds
  s_add_u32 s45, s45, 0x2000
L_sd_1:
  s_branch L_h_pre
L_h_go:
  s_mov_b32 s50, 0xfffffff9
.p2align 6
L_h_loop:
  s_setprio 0
  v_add_u32 v11, s55, v6
  v_add_u32 v12, s55, v7
  v_add_u32 v240, s55, v8
  v_xor_b32 v241, 32, v240
  v_xor_b32 v245, 64, v240
  v_xor_b32 v246, 96, v240
  s_add_u32 s55, s55, 0x8000
  s_and_b32 s55, s55, 0xffff
  ds_read_b128 v[48:51], v11 offset:0
  ds_read_b128 v[52:55], v12 offset:0
  ds_read_b128 v[56:59], v11 offset:4096
  ds_read_b128 v[60:63], v12 offset:4096
  ds_read_b128 v[64:67], v11 offset:2048
  ds_read_b128 v[68:71], v12 offset:2048
  ds_read_b128 v[72:75], v11 offset:6144
  ds_read_b128 v[76:79], v12 offset:6144
  s_waitcnt lgkmcnt(4)
  s_setprio 2
  v_mfma_f32_16x16x32_bf16 v[36:39], v[48:51], v[16:19], v[32:35]
  v_mfma_f32_16x16x32_bf16 v[36:39], v[52:55], v[20:23], v[36:39]
  v_mfma_f32_16x16x32_bf16 v[36:39], v[56:59], v[24:27], v[36:39]
  v_mfma_f32_16x16x32_bf16 v[36:39], v[60:63], v[28:31], v[36:39]
  s_setprio 0
  ds_read_b64_tr_b16 v[80:81], v240 offset:0
  ds_read_b64_tr_b16 v[82:83], v240 offset:2048
  ds_read_b64_tr_b16 v[84:85], v241 offset:0
  ds_read_b64_tr_b16 v[86:87], v241 offset:2048
  ds_read_b64_tr_b16 v[88:89], v245 offset:0
  ds_read_b64_tr_b16 v[90:91], v245 offset:2048
  ds_read_b64_tr_b16 v[92:93], v246 offset:0
  ds_read_b64_tr_b16 v[94:95], v246 offset:2048
  s_setprio 2
  buffer_load_dwordx4 v243, s[24:27], s47 offen offset:2048 nt lds
  buffer_load_dwordx4 v244, s[24:27], s47 offen offset:3072 nt lds
  s_sub_u32 s41, s41, 1
  s_cmp_ge_u32 s41, 29
  s_cbranch_scc1 L_sk_2
  s_waitcnt vmcnt(20) lgkmcnt(0)
  s_barrier
L_si_2:
  s_and_b32 s46, s45, 0xffff
  s_add_u32 s46, s46, s43
  s_cmp_lt_u32 s45, 0x40000
  s_cselect_b32 m0, s46, s53
  s_add_u32 s47, s45, s52
  buffer_load_dwordx4 v4, s[24:27], s47 offen offset:0 nt lds
  buffer_load_dwordx4 v5, s[24:27], s47 offen offset:1024 nt lds
  s_add_u32 s45, s45, 0x2000
L_sd_2:
  v_mfma_f32_16x16x32_bf16 v[40:43], v[64:67], v[16:19], v[32:35]
  v_mfma_f32_16x16x32_bf16 v[40:43], v[68:71], v[20:23], v[40:43]
  v_mfma_f32_16x16x32_bf16 v[40:43], v[72:75], v[24:27], v[40:43]
  v_mfma_f32_16x16x32_bf16 v[40:43], v[76:79], v[28:31], v[40:43]
  s_setprio 0
  ds_read_b64_tr_b16 v[96:97], v240 offset:4096
  ds_read_b64_tr_b16 v[98:99], v240 offset:6144
  ds_read_b64_tr_b16 v[100:101], v241 offset:4096
  ds_read_b64_tr_b16 v[102:103], v241 offset:6144
  ds_read_b64_tr_b16 v[104:105], v245 offset:4096
  ds_read_b64_tr_b16 v[106:107], v245 offset:6144
  ds_read_b64_tr_b16 v[108:109], v246 offset:4096
  ds_read_b64_tr_b16 v[110:111], v246 offset:6144
  v_exp_f32 v36, v36
  v_exp_f32 v37, v37
  v_exp_f32 v38, v38
  v_exp_f32 v39, v39
  s_nop 0
  v_add_f32 v10, v10, v36
  v_add_f32 v10, v10, v37
  v_add_f32 v10, v10, v38
  v_add_f32 v10, v10, v39
  v_cvt_pk_bf16_f32 v44, v36, v37
  v_cvt_pk_bf16_f32 v45, v38, v39
  s_setprio 2
  buffer_load_dwordx4 v243, s[24:27], s47 offen offset:2048 nt lds
  buffer_load_dwordx4 v244, s[24:27], s47 offen offset:3072 nt lds
  s_sub_u32 s41, s41, 1
  s_cmp_ge_u32 s41, 29
  s_cbranch_scc1 L_sk_3
  s_waitcnt vmcnt(20) lgkmcnt(0)
  s_barrier
L_si_3:
  s_and_b32 s46, s45, 0xffff
  s_add_u32 s46, s46, s43
  s_cmp_lt_u32 s45, 0x40000
  s_cselect_b32 m0, s46, s53
  s_add_u32 s47, s45, s52
  buffer_load_dwordx4 v4, s[24:27], s47 offen offset:0 nt lds
  buffer_load_dwordx4 v5, s[24:27], s47 offen offset:1024 nt lds
  s_add_u32 s45, s45, 0x2000
L_sd_3:
  s_setprio 0
  v_exp_f32 v40, v40
  v_exp_f32 v41, v41
  v_exp_f32 v42, v42
  v_exp_f32 v43, v43
  s_nop 0
  v_add_f32 v10, v10, v40
  v_add_f32 v10, v10, v41
  v_add_f32 v10, v10, v42
  v_add_f32 v10, v10, v43
  v_cvt_pk_bf16_f32 v46, v40, v41
  v_cvt_pk_bf16_f32 v47, v42, v43
  s_setprio 2
  s_nop 1
  v_mfma_f32_16x16x32_bf16 v[112:115], v[80:83], v[44:47], v[112:115]
  v_mfma_f32_16x16x32_bf16 v[116:119], v[84:87], v[44:47], v[116:119]
  v_mfma_f32_16x16x32_bf16 v[120:123], v[88:91], v[44:47], v[120:123]
  v_mfma_f32_16x16x32_bf16 v[124:127], v[92:95], v[44:47], v[124:127]
  buffer_load_dwordx4 v243, s[24:27], s47 offen offset:2048 nt lds
  buffer_load_dwordx4 v244, s[24:27], s47 offen offset:3072 nt lds
  s_sub_u32 s41, s41, 1
  s_cmp_ge_u32 s41, 29
  s_cbranch_scc1 L_sk_4
  s_waitcnt vmcnt(20) lgkmcnt(0)
  s_barrier
L_si_4:
  s_and_b32 s46, s45, 0xffff
  s_add_u32 s46, s46, s43
  s_cmp_lt_u32 s45, 0x40000
  s_cselect_b32 m0, s46, s53
  s_add_u32 s47, s45, s52
  buffer_load_dwordx4 v4, s[24:27], s47 offen offset:0 nt lds
  buffer_load_dwordx4 v5, s[24:27], s47 offen offset:1024 nt lds
  s_add_u32 s45, s45, 0x2000
L_sd_4:
  v_mfma_f32_16x16x32_bf16 v[128:131], v[96:99], v[44:47], v[128:131]
  v_mfma_f32_16x16x32_bf16 v[132:135], v[100:103], v[44:47], v[132:135]
  v_mfma_f32_16x16x32_bf16 v[136:139], v[104:107], v[44:47], v[136:139]
  v_mfma_f32_16x16x32_bf16 v[140:143], v[108:111], v[44:47], v[140:143]
  buffer_load_dwordx4 v243, s[24:27], s47 offen offset:2048 nt lds
  buffer_load_dwordx4 v244, s[24:27], s47 offen offset:3072 nt lds
  s_sub_u32 s41, s41, 1
  s_cmp_ge_u32 s41, 29
  s_cbranch_scc1 L_sk_5
  s_waitcnt vmcnt(20) lgkmcnt(0)
  s_barrier
L_si_5:
  s_and_b32 s46, s45, 0xffff
  s_add_u32 s46, s46, s43
  s_cmp_lt_u32 s45, 0x40000
  s_cselect_b32 m0, s46, s53
  s_add_u32 s47, s45, s52
  buffer_load_dwordx4 v4, s[24:27], s47 offen offset:0 nt lds
  buffer_load_dwordx4 v5, s[24:27], s47 offen offset:1024 nt lds
  s_add_u32 s45, s45, 0x2000
L_sd_5:
  s_add_u32 s50, s50, 1
  s_cbranch_scc0 L_h_loop
  v_add_u32 v11, s55, v6
  v_add_u32 v12, s55, v7
  v_add_u32 v240, s55, v8
  v_xor_b32 v241, 32, v240
  v_xor_b32 v245, 64, v240
  v_xor_b32 v246, 96, v240
  s_add_u32 s55, s55, 0x8000
  s_and_b32 s55, s55, 0xffff
  ds_read_b128 v[48:51], v11 offset:0
  ds_read_b128 v[52:55], v12 offset:0
  ds_read_b128 v[56:59], v11 offset:4096
  ds_read_b128 v[60:63], v12 offset:4096
  ds_read_b128 v[64:67], v11 offset:2048
  ds_read_b128 v[68:71], v12 offset:2048
  ds_read_b128 v[72:75], v11 offset:6144
  ds_read_b128 v[76:79], v12 offset:6144
  s_waitcnt lgkmcnt(4)
  v_mfma_f32_16x16x32_bf16 v[36:39], v[48:51], v[16:19], v[32:35]
  v_mfma_f32_16x16x32_bf16 v[36:39], v[52:55], v[20:23], v[36:39]
  v_mfma_f32_16x16x32_bf16 v[36:39], v[56:59], v[24:27], v[36:39]
  v_mfma_f32_16x16x32_bf16 v[36:39], v[60:63], v[28:31], v[36:39]
  ds_read_b64_tr_b16 v[80:81], v240 offset:0
  ds_read_b64_tr_b16 v[82:83], v240 offset:2048
  ds_read_b64_tr_b16 v[84:85], v241 offset:0
  ds_read_b64_tr_b16 v[86:87], v241 offset:2048
  ds_read_b64_tr_b16 v[88:89], v245 offset:0
  ds_read_b64_tr_b16 v[90:91], v245 offset:2048
  ds_read_b64_tr_b16 v[92:93], v246 offset:0
  ds_read_b64_tr_b16 v[94:95], v246 offset:2048
  buffer_load_dwordx4 v243, s[24:27], s47 offen offset:2048 nt lds
  buffer_load_dwordx4 v244, s[24:27], s47 offen offset:3072 nt lds
  s_sub_u32 s41, s41, 1
  s_cmp_ge_u32 s41, 29
  s_cbranch_scc1 L_sk_6
  s_waitcnt vmcnt(20) lgkmcnt(0)
  s_barrier
L_si_6:
  s_and_b32 s46, s45, 0xffff
  s_add_u32 s46, s46, s43
  s_cmp_lt_u32 s45, 0x40000
  s_cselect_b32 m0, s46, s53
  s_add_u32 s47, s45, s52
  buffer_load_dwordx4 v4, s[24:27], s47 offen offset:0 nt lds
  buffer_load_dwordx4 v5, s[24:27], s47 offen offset:1024 nt lds
  s_add_u32 s45, s45, 0x2000
L_sd_6:
  v_mfma_f32_16x16x32_bf16 v[40:43], v[64:67], v[16:19], v[32:35]
  v_mfma_f32_16x16x32_bf16 v[40:43], v[68:71], v[20:23], v[40:43]
  v_mfma_f32_16x16x32_bf16 v[40:43], v[72:75], v[24:27], v[40:43]
  v_mfma_f32_16x16x32_bf16 v[40:43], v[76:79], v[28:31], v[40:43]
  ds_read_b64_tr_b16 v[96:97], v240 offset:4096
  ds_read_b64_tr_b16 v[98:99], v240 offset:6144
  ds_read_b64_tr_b16 v[100:101], v241 offset:4096
  ds_read_b64_tr_b16 v[102:103], v241 offset:6144
  ds_read_b64_tr_b16 v[104:105], v245 offset:4096
  ds_read_b64_tr_b16 v[106:107], v245 offset:6144
  ds_read_b64_tr_b16 v[108:109], v246 offset:4096
  ds_read_b64_tr_b16 v[110:111], v246 offset:6144
  v_exp_f32 v36, v36
  v_exp_f32 v37, v37
  v_exp_f32 v38, v38
  v_exp_f32 v39, v39
  s_nop 0
  v_add_f32 v10, v10, v36
  v_add_f32 v10, v10, v37
  v_add_f32 v10, v10, v38
  v_add_f32 v10, v10, v39
  v_cvt_pk_bf16_f32 v44, v36, v37
  v_cvt_pk_bf16_f32 v45, v38, v39
  buffer_load_dwordx4 v243, s[24:27], s47 offen offset:2048 nt lds
  buffer_load_dwordx4 v244, s[24:27], s47 offen offset:3072 nt lds
  s_sub_u32 s41, s41, 1
  s_cmp_ge_u32 s41, 29
  s_cbranch_scc1 L_sk_7
  s_waitcnt vmcnt(20) lgkmcnt(0)
  s_barrier
L_si_7:
  s_and_b32 s46, s45, 0xffff
  s_add_u32 s46, s46, s43
  s_cmp_lt_u32 s45, 0x40000
  s_cselect_b32 m0, s46, s53
  s_add_u32 s47, s45, s52
  buffer_load_dwordx4 v4, s[24:27], s47 offen offset:0 nt lds
  buffer_load_dwordx4 v5, s[24:27], s47 offen offset:1024 nt lds
  s_add_u32 s45, s45, 0x2000
L_sd_7:
  v_exp_f32 v40, v40
  v_exp_f32 v41, v41
  v_exp_f32 v42, v42
  v_exp_f32 v43, v43
  s_nop 0
  v_add_f32 v10, v10, v40
  v_add_f32 v10, v10, v41
  v_add_f32 v10, v10, v42
  v_add_f32 v10, v10, v43
  v_cvt_pk_bf16_f32 v46, v40, v41
  v_cvt_pk_bf16_f32 v47, v42, v43
  s_nop 1
  v_mfma_f32_16x16x32_bf16 v[112:115], v[80:83], v[44:47], v[112:115]
  v_mfma_f32_16x16x32_bf16 v[116:119], v[84:87], v[44:47], v[116:119]
  v_mfma_f32_16x16x32_bf16 v[120:123], v[88:91], v[44:47], v[120:123]
  v_mfma_f32_16x16x32_bf16 v[124:127], v[92:95], v[44:47], v[124:127]
  buffer_load_dwordx4 v243, s[24:27], s47 offen offset:2048 nt lds
  buffer_load_dwordx4 v244, s[24:27], s47 offen offset:3072 nt lds
  s_sub_u32 s41, s41, 1
  s_cmp_ge_u32 s41, 29
  s_cbranch_scc1 L_sk_8
  s_waitcnt vmcnt(20) lgkmcnt(0)
  s_barrier
L_si_8:
  s_and_b32 s46, s45, 0xffff
  s_add_u32 s46, s46, s43
  s_cmp_lt_u32 s45, 0x40000
  s_cselect_b32 m0, s46, s53
  s_add_u32 s47, s45, s52
  buffer_load_dwordx4 v4, s[24:27], s47 offen offset:0 nt lds
  buffer_load_dwordx4 v5, s[24:27], s47 offen offset:1024 nt lds
  s_add_u32 s45, s45, 0x2000
L_sd_8:
  v_mfma_f32_16x16x32_bf16 v[128:131], v[96:99], v[44:47], v[128:131]
  v_mfma_f32_16x16x32_bf16 v[132:135], v[100:103], v[44:47], v[132:135]
  v_mfma_f32_16x16x32_bf16 v[136:139], v[104:107], v[44:47], v[136:139]
  v_mfma_f32_16x16x32_bf16 v[140:143], v[108:111], v[44:47], v[140:143]
  buffer_load_dwordx4 v243, s[24:27], s47 offen offset:2048 nt lds
  buffer_load_dwordx4 v244, s[24:27], s47 offen offset:3072 nt lds
  s_sub_u32 s41, s41, 1
  s_cmp_ge_u32 s41, 29
  s_cbranch_scc1 L_sk_9
  s_waitcnt vmcnt(20) lgkmcnt(0)
  s_barrier
L_si_9:
  s_and_b32 s46, s45, 0xffff
  s_add_u32 s46, s46, s43
  s_cmp_lt_u32 s45, 0x40000
  s_cselect_b32 m0, s46, s53
  s_add_u32 s47, s45, s52
  buffer_load_dwordx4 v4, s[24:27], s47 offen offset:0 nt lds
  buffer_load_dwordx4 v5, s[24:27], s47 offen offset:1024 nt lds
  s_add_u32 s45, s45, 0x2000
L_sd_9:
  s_branch L_h_fin
L_sk_1:
  s_cmp_gt_u32 s41, 30
  s_cbranch_scc1 L_st_1
  s_cmp_eq_u32 s41, 29
  s_cbranch_scc1 L_sr_1
  s_waitcnt vmcnt(12)
L_sr_1:
  s_waitcnt vmcnt(16) lgkmcnt(0)
  s_barrier
  s_and_b32 s46, s45, 0xffff
  s_add_u32 s46, s46, s43
  s_cmp_lt_u32 s45, 0x40000
  s_cselect_b32 m0, s46, s53
  s_add_u32 s47, s45, s52
  buffer_load_dwordx4 v4, s[24:27], s47 offen offset:0 nt lds
  buffer_load_dwordx4 v5, s[24:27], s47 offen offset:1024 nt lds
  buffer_load_dwordx4 v243, s[24:27], s47 offen offset:2048 nt lds
  buffer_load_dwordx4 v244, s[24:27], s47 offen offset:3072 nt lds
  s_add_u32 s45, s45, 0x2000
  s_branch L_si_1
L_st_1:
  s_mov_b32 s41, 0
  s_waitcnt lgkmcnt(0)
  s_nop 7
  s_branch L_sd_1
L_sk_2:
  s_cmp_gt_u32 s41, 30
  s_cbranch_scc1 L_st_2
  s_cmp_eq_u32 s41, 29
  s_cbranch_scc1 L_sr_2
  s_waitcnt vmcnt(12)
L_sr_2:
  s_waitcnt vmcnt(16) lgkmcnt(0)
  s_barrier
  s_and_b32 s46, s45, 0xffff
  s_add_u32 s46, s46, s43
  s_cmp_lt_u32 s45, 0x40000
  s_cselect_b32 m0, s46, s53
  s_add_u32 s47, s45, s52
  buffer_load_dwordx4 v4, s[24:27], s47 offen offset:0 nt lds
  buffer_load_dwordx4 v5, s[24:27], s47 offen offset:1024 nt lds
  buffer_load_dwordx4 v243, s[24:27], s47 offen offset:2048 nt lds
  buffer_load_dwordx4 v244, s[24:27], s47 offen offset:3072 nt lds
  s_add_u32 s45, s45, 0x2000
  s_branch L_si_2
L_st_2:
  s_mov_b32 s41, 0
  s_waitcnt lgkmcnt(0)
  s_nop 7
  s_branch L_sd_2
L_sk_3:
  s_cmp_gt_u32 s41, 30
  s_cbranch_scc1 L_st_3
  s_cmp_eq_u32 s41, 29
  s_cbranch_scc1 L_sr_3
  s_waitcnt vmcnt(12)
L_sr_3:
  s_waitcnt vmcnt(16) lgkmcnt(0)
  s_barrier
  s_and_b32 s46, s45, 0xffff
  s_add_u32 s46, s46, s43
  s_cmp_lt_u32 s45, 0x40000
  s_cselect_b32 m0, s46, s53
  s_add_u32 s47, s45, s52
  buffer_load_dwordx4 v4, s[24:27], s47 offen offset:0 nt lds
  buffer_load_dwordx4 v5, s[24:27], s47 offen offset:1024 nt lds
  buffer_load_dwordx4 v243, s[24:27], s47 offen offset:2048 nt lds
  buffer_load_dwordx4 v244, s[24:27], s47 offen offset:3072 nt lds
  s_add_u32 s45, s45, 0x2000
  s_branch L_si_3
L_st_3:
  s_mov_b32 s41, 0
  s_waitcnt lgkmcnt(0)
  s_nop 7
  s_branch L_sd_3
L_sk_4:
  s_cmp_gt_u32 s41, 30
  s_cbranch_scc1 L_st_4
  s_cmp_eq_u32 s41, 29
  s_cbranch_scc1 L_sr_4
  s_waitcnt vmcnt(12)
L_sr_4:
  s_waitcnt vmcnt(16) lgkmcnt(0)
  s_barrier
  s_and_b32 s46, s45, 0xffff
  s_add_u32 s46, s46, s43
  s_cmp_lt_u32 s45, 0x40000
  s_cselect_b32 m0, s46, s53
  s_add_u32 s47, s45, s52
  buffer_load_dwordx4 v4, s[24:27], s47 offen offset:0 nt lds
  buffer_load_dwordx4 v5, s[24:27], s47 offen offset:1024 nt lds
  buffer_load_dwordx4 v243, s[24:27], s47 offen offset:2048 nt lds
  buffer_load_dwordx4 v244, s[24:27], s47 offen offset:3072 nt lds
  s_add_u32 s45, s45, 0x2000
  s_branch L_si_4
L_st_4:
  s_mov_b32 s41, 0
  s_waitcnt lgkmcnt(0)
  s_nop 7
  s_branch L_sd_4
L_sk_5:
  s_cmp_gt_u32 s41, 30
  s_cbranch_scc1 L_st_5
  s_cmp_eq_u32 s41, 29
  s_cbranch_scc1 L_sr_5
  s_waitcnt vmcnt(12)
L_sr_5:
  s_waitcnt vmcnt(16) lgkmcnt(0)
  s_barrier
  s_and_b32 s46, s45, 0xffff
  s_add_u32 s46, s46, s43
  s_cmp_lt_u32 s45, 0x40000
  s_cselect_b32 m0, s46, s53
  s_add_u32 s47, s45, s52
  buffer_load_dwordx4 v4, s[24:27], s47 offen offset:0 nt lds
  buffer_load_dwordx4 v5, s[24:27], s47 offen offset:1024 nt lds
  buffer_load_dwordx4 v243, s[24:27], s47 offen offset:2048 nt lds
  buffer_load_dwordx4 v244, s[24:27], s47 offen offset:3072 nt lds
  s_add_u32 s45, s45, 0x2000
  s_branch L_si_5
L_st_5:
  s_mov_b32 s41, 0
  s_waitcnt lgkmcnt(0)
  s_nop 7
  s_branch L_sd_5
L_sk_6:
  s_cmp_gt_u32 s41, 30
  s_cbranch_scc1 L_st_6
  s_cmp_eq_u32 s41, 29
  s_cbranch_scc1 L_sr_6
  s_waitcnt vmcnt(12)
L_sr_6:
  s_waitcnt vmcnt(16) lgkmcnt(0)
  s_barrier
  s_and_b32 s46, s45, 0xffff
  s_add_u32 s46, s46, s43
  s_cmp_lt_u32 s45, 0x40000
  s_cselect_b32 m0, s46, s53
  s_add_u32 s47, s45, s52
  buffer_load_dwordx4 v4, s[24:27], s47 offen offset:0 nt lds
  buffer_load_dwordx4 v5, s[24:27], s47 offen offset:1024 nt lds
  buffer_load_dwordx4 v243, s[24:27], s47 offen offset:2048 nt lds
  buffer_load_dwordx4 v244, s[24:27], s47 offen offset:3072 nt lds
  s_add_u32 s45, s45, 0x2000
  s_branch L_si_6
L_st_6:
  s_mov_b32 s41, 0
  s_waitcnt lgkmcnt(0)
  s_nop 7
  s_branch L_sd_6
L_sk_7:
  s_cmp_gt_u32 s41, 30
  s_cbranch_scc1 L_st_7
  s_cmp_eq_u32 s41, 29
  s_cbranch_scc1 L_sr_7
  s_waitcnt vmcnt(12)
L_sr_7:
  s_waitcnt vmcnt(16) lgkmcnt(0)
  s_barrier
  s_and_b32 s46, s45, 0xffff
  s_add_u32 s46, s46, s43
  s_cmp_lt_u32 s45, 0x40000
  s_cselect_b32 m0, s46, s53
  s_add_u32 s47, s45, s52
  buffer_load_dwordx4 v4, s[24:27], s47 offen offset:0 nt lds
  buffer_load_dwordx4 v5, s[24:27], s47 offen offset:1024 nt lds
  buffer_load_dwordx4 v243, s[24:27], s47 offen offset:2048 nt lds
  buffer_load_dwordx4 v244, s[24:27], s47 offen offset:3072 nt lds
  s_add_u32 s45, s45, 0x2000
  s_branch L_si_7
L_st_7:
  s_mov_b32 s41, 0
  s_waitcnt lgkmcnt(0)
  s_nop 7
  s_branch L_sd_7
L_sk_8:
  s_cmp_gt_u32 s41, 30
  s_cbranch_scc1 L_st_8
  s_cmp_eq_u32 s41, 29
  s_cbranch_scc1 L_sr_8
  s_waitcnt vmcnt(12)
L_sr_8:
  s_waitcnt vmcnt(16) lgkmcnt(0)
  s_barrier
  s_and_b32 s46, s45, 0xffff
  s_add_u32 s46, s46, s43
  s_cmp_lt_u32 s45, 0x40000
  s_cselect_b32 m0, s46, s53
  s_add_u32 s47, s45, s52
  buffer_load_dwordx4 v4, s[24:27], s47 offen offset:0 nt lds
  buffer_load_dwordx4 v5, s[24:27], s47 offen offset:1024 nt lds
  buffer_load_dwordx4 v243, s[24:27], s47 offen offset:2048 nt lds
  buffer_load_dwordx4 v244, s[24:27], s47 offen offset:3072 nt lds
  s_add_u32 s45, s45, 0x2000
  s_branch L_si_8
L_st_8:
  s_mov_b32 s41, 0
  s_waitcnt lgkmcnt(0)
  s_nop 7
  s_branch L_sd_8
L_sk_9:
  s_cmp_gt_u32 s41, 30
  s_cbranch_scc1 L_st_9
  s_cmp_eq_u32 s41, 29
  s_cbranch_scc1 L_sr_9
  s_waitcnt vmcnt(12)
L_sr_9:
  s_waitcnt vmcnt(16) lgkmcnt(0)
  s_barrier
  s_and_b32 s46, s45, 0xffff
  s_add_u32 s46, s46, s43
  s_cmp_lt_u32 s45, 0x40000
  s_cselect_b32 m0, s46, s53
  s_add_u32 s47, s45, s52
  buffer_load_dwordx4 v4, s[24:27], s47 offen offset:0 nt lds
  buffer_load_dwordx4 v5, s[24:27], s47 offen offset:1024 nt lds
  buffer_load_dwordx4 v243, s[24:27], s47 offen offset:2048 nt lds
  buffer_load_dwordx4 v244, s[24:27], s47 offen offset:3072 nt lds
  s_add_u32 s45, s45, 0x2000
  s_branch L_si_9
L_st_9:
  s_mov_b32 s41, 0
  s_waitcnt lgkmcnt(0)
  s_nop 7
  s_branch L_sd_9
L_h_fin:
  v_mov_b32 v14, v10
  s_nop 1
  v_permlane32_swap_b32 v10, v14
  v_add_f32 v10, v10, v14
  v_mov_b32 v14, v10
  s_nop 1
  v_permlane16_swap_b32 v10, v14
  v_add_f32 v10, v10, v14
  s_lshl_b32 s46, s42, 13
  s_add_u32 s46, s46, 0x10000
  v_lshlrev_b32 v13, 4, v1
  v_add_u32 v14, s46, v13
  s_nop 4
  ds_write_b128 v14, v[112:115] offset:0
  ds_write_b128 v14, v[116:119] offset:1024
  ds_write_b128 v14, v[120:123] offset:2048
  ds_write_b128 v14, v[124:127] offset:3072
  ds_write_b128 v14, v[128:131] offset:4096
  ds_write_b128 v14, v[132:135] offset:5120
  ds_write_b128 v14, v[136:139] offset:6144
  ds_write_b128 v14, v[140:143] offset:7168
  s_lshl_b32 s46, s42, 8
  s_add_u32 s46, s46, 0x20000
  v_lshlrev_b32 v15, 2, v1
  v_add_u32 v14, s46, v15
  ds_write_b32 v14, v10
  s_waitcnt lgkmcnt(0)
  v_mov_b32 v14, 0x20400
  v_mov_b32 v12, 1
  s_mov_b64 exec, 1
  ds_add_u32 v14, v12
  s_mov_b64 exec, -1
  s_setprio 0
L_h_spin:
  s_sleep 1
  ds_read_b32 v12, v14
  s_waitcnt lgkmcnt(0)
  v_readfirstlane_b32 s46, v12
  s_nop 3
  s_cmp_lt_u32 s46, 4
  s_cbranch_scc1 L_h_spin
  s_setprio 2
  s_lshl_b32 s46, s42, 11
  s_add_u32 s46, s46, 0x10000
  v_add_u32 v14, s46, v13
  ds_read_b128 v[144:147], v14 offset:0
  ds_read_b128 v[148:151], v14 offset:1024
  ds_read_b128 v[152:155], v14 offset:8192
  ds_read_b128 v[156:159], v14 offset:9216
  ds_read_b128 v[160:163], v14 offset:16384
  ds_read_b128 v[164:167], v14 offset:17408
  ds_read_b128 v[168:171], v14 offset:24576
  ds_read_b128 v[172:175], v14 offset:25600
  v_add_u32 v14, 0x20000, v15
  ds_read_b32 v48, v14 offset:0
  ds_read_b32 v49, v14 offset:256
  ds_read_b32 v50, v14 offset:512
  ds_read_b32 v51, v14 offset:768
  s_waitcnt lgkmcnt(0)
  v_add_f32 v13, v48, v49
  v_add_f32 v14, v50, v51
  v_add_f32 v13, v13, v14
  v_cmp_nlt_f32 vcc, v13, s49
  v_rcp_f32 v15, v13
  s_nop 3
  s_cbranch_vccnz L_h_bad
  v_add_f32 v144, v144, v152
  v_add_f32 v160, v160, v168
  v_add_f32 v144, v144, v160
  v_mul_f32 v144, v144, v15
  v_add_f32 v145, v145, v153
  v_add_f32 v161, v161, v169
  v_add_f32 v145, v145, v161
  v_mul_f32 v145, v145, v15
  v_add_f32 v146, v146, v154
  v_add_f32 v162, v162, v170
  v_add_f32 v146, v146, v162
  v_mul_f32 v146, v146, v15
  v_add_f32 v147, v147, v155
  v_add_f32 v163, v163, v171
  v_add_f32 v147, v147, v163
  v_mul_f32 v147, v147, v15
  v_add_f32 v148, v148, v156
  v_add_f32 v164, v164, v172
  v_add_f32 v148, v148, v164
  v_mul_f32 v148, v148, v15
  v_add_f32 v149, v149, v157
  v_add_f32 v165, v165, v173
  v_add_f32 v149, v149, v165
  v_mul_f32 v149, v149, v15
  v_add_f32 v150, v150, v158
  v_add_f32 v166, v166, v174
  v_add_f32 v150, v150, v166
  v_mul_f32 v150, v150, v15
  v_add_f32 v151, v151, v159
  v_add_f32 v167, v167, v175
  v_add_f32 v151, v151, v167
  v_mul_f32 v151, v151, v15
  v_cvt_pk_bf16_f32 v56, v144, v145
  v_cvt_pk_bf16_f32 v57, v146, v147
  v_cvt_pk_bf16_f32 v58, v148, v149
  v_cvt_pk_bf16_f32 v59, v150, v151
  v_lshlrev_b32 v14, 8, v2
  v_lshl_add_u32 v14, v3, 3, v14
  s_lshl_b32 s46, s42, 6
  s_add_u32 s46, s46, 0x8000
  v_add_u32 v14, s46, v14
  buffer_store_dwordx2 v[56:57], v14, s[20:23], s35 offen offset:0 nt
  buffer_store_dwordx2 v[58:59], v14, s[20:23], s35 offen offset:32 nt
L_end:
  s_endpgm
L_h_bad:
  s_cmp_lg_u32 s42, 0
  s_cbranch_scc1 L_end
  s_mov_b32 s58, 128
  s_mov_b32 s59, 32768
  s_mov_b32 s56, 0x0000ffff
  s_mov_b32 s57, 0x0000ffff
L_slow:
  s_waitcnt vmcnt(0) lgkmcnt(0)
  s_nop 7
  s_nop 7
  v_and_b32 v2, 31, v1
  v_lshrrev_b32 v3, 5, v1
  v_lshlrev_b32 v4, 8, v2
  v_lshl_add_u32 v4, v3, 4, v4
  s_lshl_b32 s46, s58, 8
  v_add_u32 v12, s46, v4
  buffer_load_dwordx4 v[16:19], v12, s[8:11], s35 offen offset:0
  buffer_load_dwordx4 v[20:23], v12, s[8:11], s35 offen offset:32
  buffer_load_dwordx4 v[24:27], v12, s[8:11], s35 offen offset:64
  buffer_load_dwordx4 v[28:31], v12, s[8:11], s35 offen offset:96
  buffer_load_dwordx4 v[32:35], v12, s[8:11], s35 offen offset:128
  buffer_load_dwordx4 v[36:39], v12, s[8:11], s35 offen offset:160
  buffer_load_dwordx4 v[40:43], v12, s[8:11], s35 offen offset:192
  buffer_load_dwordx4 v[44:47], v12, s[8:11], s35 offen offset:224
  v_bfe_u32 v13, v1, 4, 1
  v_lshlrev_b32 v13, 2, v13
  v_lshl_add_u32 v13, v3, 1, v13
  v_and_b32 v14, 7, v1
  v_xor_b32 v13, v13, v14
  v_lshlrev_b32 v13, 4, v13
  v_lshrrev_b32 v14, 3, v1
  v_lshl_add_u32 v5, v14, 8, v13
  v_bfe_u32 v13, v1, 2, 2
  v_lshl_add_u32 v14, v3, 2, v13
  v_lshlrev_b32 v14, 7, v14
  v_lshrrev_b32 v13, 1, v13
  v_lshl_add_u32 v14, v13, 6, v14
  v_bfe_u32 v13, v1, 4, 1
  v_xor_b32 v13, v13, v3
  v_lshl_add_u32 v14, v13, 5, v14
  v_and_b32 v13, 3, v1
  v_lshl_add_u32 v14, v13, 3, v14
  v_add_u32 v8, s59, v14
  v_xor_b32 v9, 64, v8
  s_waitcnt vmcnt(0)
  v_lshlrev_b32 v13, 16, v16
  v_and_b32 v14, 0xffff0000, v16
  v_lshlrev_b32 v15, 16, v17
  v_and_b32 v2, 0xffff0000, v17
  v_mul_f32 v13, s37, v13
  v_mul_f32 v14, s37, v14
  v_mul_f32 v15, s37, v15
  v_mul_f32 v2, s37, v2
  v_cvt_pk_bf16_f32 v16, v13, v14
  v_cvt_pk_bf16_f32 v17, v15, v2
  v_lshlrev_b32 v13, 16, v18
  v_and_b32 v14, 0xffff0000, v18
  v_lshlrev_b32 v15, 16, v19
  v_and_b32 v2, 0xffff0000, v19
  v_mul_f32 v13, s37, v13
  v_mul_f32 v14, s37, v14
  v_mul_f32 v15, s37, v15
  v_mul_f32 v2, s37, v2
  v_cvt_pk_bf16_f32 v18, v13, v14
  v_cvt_pk_bf16_f32 v19, v15, v2
  v_lshlrev_b32 v13, 16, v20
  v_and_b32 v14, 0xffff0000, v20
  v_lshlrev_b32 v15, 16, v21
  v_and_b32 v2, 0xffff0000, v21
  v_mul_f32 v13, s37, v13
  v_mul_f32 v14, s37, v14
  v_mul_f32 v15, s37, v15
  v_mul_f32 v2, s37, v2
  v_cvt_pk_bf16_f32 v20, v13, v14
  v_cvt_pk_bf16_f32 v21, v15, v2
  v_lshlrev_b32 v13, 16, v22
  v_and_b32 v14, 0xffff0000, v22
  v_lshlrev_b32 v15, 16, v23
  v_and_b32 v2, 0xffff0000, v23
  v_mul_f32 v13, s37, v13
  v_mul_f32 v14, s37, v14
  v_mul_f32 v15, s37, v15
  v_mul_f32 v2, s37, v2
  v_cvt_pk_bf16_f32 v22, v13, v14
  v_cvt_pk_bf16_f32 v23, v15, v2
  v_lshlrev_b32 v13, 16, v24
  v_and_b32 v14, 0xffff0000, v24
  v_lshlrev_b32 v15, 16, v25
  v_and_b32 v2, 0xffff0000, v25
  v_mul_f32 v13, s37, v13
  v_mul_f32 v14, s37, v14
  v_mul_f32 v15, s37, v15
  v_mul_f32 v2, s37, v2
  v_cvt_pk_bf16_f32 v24, v13, v14
  v_cvt_pk_bf16_f32 v25, v15, v2
  v_lshlrev_b32 v13, 16, v26
  v_and_b32 v14, 0xffff0000, v26
  v_lshlrev_b32 v15, 16, v27
  v_and_b32 v2, 0xffff0000, v27
  v_mul_f32 v13, s37, v13
  v_mul_f32 v14, s37, v14
  v_mul_f32 v15, s37, v15
  v_mul_f32 v2, s37, v2
  v_cvt_pk_bf16_f32 v26, v13, v14
  v_cvt_pk_bf16_f32 v27, v15, v2
  v_lshlrev_b32 v13, 16, v28
  v_and_b32 v14, 0xffff0000, v28
  v_lshlrev_b32 v15, 16, v29
  v_and_b32 v2, 0xffff0000, v29
  v_mul_f32 v13, s37, v13
  v_mul_f32 v14, s37, v14
  v_mul_f32 v15, s37, v15
  v_mul_f32 v2, s37, v2
  v_cvt_pk_bf16_f32 v28, v13, v14
  v_cvt_pk_bf16_f32 v29, v15, v2
  v_lshlrev_b32 v13, 16, v30
  v_and_b32 v14, 0xffff0000, v30
  v_lshlrev_b32 v15, 16, v31
  v_and_b32 v2, 0xffff0000, v31
  v_mul_f32 v13, s37, v13
  v_mul_f32 v14, s37, v14
  v_mul_f32 v15, s37, v15
  v_mul_f32 v2, s37, v2
  v_cvt_pk_bf16_f32 v30, v13, v14
  v_cvt_pk_bf16_f32 v31, v15, v2
  v_lshlrev_b32 v13, 16, v32
  v_and_b32 v14, 0xffff0000, v32
  v_lshlrev_b32 v15, 16, v33
  v_and_b32 v2, 0xffff0000, v33
  v_mul_f32 v13, s37, v13
  v_mul_f32 v14, s37, v14
  v_mul_f32 v15, s37, v15
  v_mul_f32 v2, s37, v2
  v_cvt_pk_bf16_f32 v32, v13, v14
  v_cvt_pk_bf16_f32 v33, v15, v2
  v_lshlrev_b32 v13, 16, v34
  v_and_b32 v14, 0xffff0000, v34
  v_lshlrev_b32 v15, 16, v35
  v_and_b32 v2, 0xffff0000, v35
  v_mul_f32 v13, s37, v13
  v_mul_f32 v14, s37, v14
  v_mul_f32 v15, s37, v15
  v_mul_f32 v2, s37, v2
  v_cvt_pk_bf16_f32 v34, v13, v14
  v_cvt_pk_bf16_f32 v35, v15, v2
  v_lshlrev_b32 v13, 16, v36
  v_and_b32 v14, 0xffff0000, v36
  v_lshlrev_b32 v15, 16, v37
  v_and_b32 v2, 0xffff0000, v37
  v_mul_f32 v13, s37, v13
  v_mul_f32 v14, s37, v14
  v_mul_f32 v15, s37, v15
  v_mul_f32 v2, s37, v2
  v_cvt_pk_bf16_f32 v36, v13, v14
  v_cvt_pk_bf16_f32 v37, v15, v2
  v_lshlrev_b32 v13, 16, v38
  v_and_b32 v14, 0xffff0000, v38
  v_lshlrev_b32 v15, 16, v39
  v_and_b32 v2, 0xffff0000, v39
  v_mul_f32 v13, s37, v13
  v_mul_f32 v14, s37, v14
  v_mul_f32 v15, s37, v15
  v_mul_f32 v2, s37, v2
  v_cvt_pk_bf16_f32 v38, v13, v14
  v_cvt_pk_bf16_f32 v39, v15, v2
  v_lshlrev_b32 v13, 16, v40
  v_and_b32 v14, 0xffff0000, v40
  v_lshlrev_b32 v15, 16, v41
  v_and_b32 v2, 0xffff0000, v41
  v_mul_f32 v13, s37, v13
  v_mul_f32 v14, s37, v14
  v_mul_f32 v15, s37, v15
  v_mul_f32 v2, s37, v2
  v_cvt_pk_bf16_f32 v40, v13, v14
  v_cvt_pk_bf16_f32 v41, v15, v2
  v_lshlrev_b32 v13, 16, v42
  v_and_b32 v14, 0xffff0000, v42
  v_lshlrev_b32 v15, 16, v43
  v_and_b32 v2, 0xffff0000, v43
  v_mul_f32 v13, s37, v13
  v_mul_f32 v14, s37, v14
  v_mul_f32 v15, s37, v15
  v_mul_f32 v2, s37, v2
  v_cvt_pk_bf16_f32 v42, v13, v14
  v_cvt_pk_bf16_f32 v43, v15, v2
  v_lshlrev_b32 v13, 16, v44
  v_and_b32 v14, 0xffff0000, v44
  v_lshlrev_b32 v15, 16, v45
  v_and_b32 v2, 0xffff0000, v45
  v_mul_f32 v13, s37, v13
  v_mul_f32 v14, s37, v14
  v_mul_f32 v15, s37, v15
  v_mul_f32 v2, s37, v2
  v_cvt_pk_bf16_f32 v44, v13, v14
  v_cvt_pk_bf16_f32 v45, v15, v2
  v_lshlrev_b32 v13, 16, v46
  v_and_b32 v14, 0xffff0000, v46
  v_lshlrev_b32 v15, 16, v47
  v_and_b32 v2, 0xffff0000, v47
  v_mul_f32 v13, s37, v13
  v_mul_f32 v14, s37, v14
  v_mul_f32 v15, s37, v15
  v_mul_f32 v2, s37, v2
  v_cvt_pk_bf16_f32 v46, v13, v14
  v_cvt_pk_bf16_f32 v47, v15, v2
  v_mov_b32 v6, 0xff800000
  s_mov_b32 s47, s36
  s_mov_b32 s41, 0
L_slow_p1:
  buffer_load_dwordx4 v[112:115], v4, s[12:15], s47 offen offset:0
  buffer_load_dwordx4 v[116:119], v4, s[12:15], s47 offen offset:32
  buffer_load_dwordx4 v[120:123], v4, s[12:15], s47 offen offset:64
  buffer_load_dwordx4 v[124:127], v4, s[12:15], s47 offen offset:96
  buffer_load_dwordx4 v[128:131], v4, s[12:15], s47 offen offset:128
  buffer_load_dwordx4 v[132:135], v4, s[12:15], s47 offen offset:160
  buffer_load_dwordx4 v[136:139], v4, s[12:15], s47 offen offset:192
  buffer_load_dwordx4 v[140:143], v4, s[12:15], s47 offen offset:224
  s_waitcnt vmcnt(0)
  v_mfma_f32_32x32x16_bf16 v[64:79], v[112:115], v[16:19], 0
  v_mfma_f32_32x32x16_bf16 v[64:79], v[116:119], v[20:23], v[64:79]
  v_mfma_f32_32x32x16_bf16 v[64:79], v[120:123], v[24:27], v[64:79]
  v_mfma_f32_32x32x16_bf16 v[64:79], v[124:127], v[28:31], v[64:79]
  v_mfma_f32_32x32x16_bf16 v[64:79], v[128:131], v[32:35], v[64:79]
  v_mfma_f32_32x32x16_bf16 v[64:79], v[132:135], v[36:39], v[64:79]
  v_mfma_f32_32x32x16_bf16 v[64:79], v[136:139], v[40:43], v[64:79]
  v_mfma_f32_32x32x16_bf16 v[64:79], v[140:143], v[44:47], v[64:79]
  s_nop 7
  s_nop 7
  v_max3_f32 v6, v6, v64, v65
  v_max3_f32 v6, v6, v66, v67
  v_max3_f32 v6, v6, v68, v69
  v_max3_f32 v6, v6, v70, v71
  v_max3_f32 v6, v6, v72, v73
  v_max3_f32 v6, v6, v74, v75
  v_max3_f32 v6, v6, v76, v77
  v_max3_f32 v6, v6, v78, v79
  s_add_u32 s47, s47, 0x2000
  s_add_u32 s41, s41, 1
  s_cmp_lt_u32 s41, 32
  s_cbranch_scc1 L_slow_p1
  v_mov_b32 v14, v6
  s_nop 1
  v_permlane32_swap_b32 v6, v14
  v_max_f32 v6, v6, v14
  v_sub_f32 v48, 0, v6
  v_sub_f32 v49, 0, v6
  v_sub_f32 v50, 0, v6
  v_sub_f32 v51, 0, v6
  v_sub_f32 v52, 0, v6
  v_sub_f32 v53, 0, v6
  v_sub_f32 v54, 0, v6
  v_sub_f32 v55, 0, v6
  v_sub_f32 v56, 0, v6
  v_sub_f32 v57, 0, v6
  v_sub_f32 v58, 0, v6
  v_sub_f32 v59, 0, v6
  v_sub_f32 v60, 0, v6
  v_sub_f32 v61, 0, v6
  v_sub_f32 v62, 0, v6
  v_sub_f32 v63, 0, v6
  v_mov_b32 v176, 0
  v_mov_b32 v177, 0
  v_mov_b32 v178, 0
  v_mov_b32 v179, 0
  v_mov_b32 v180, 0
  v_mov_b32 v181, 0
  v_mov_b32 v182, 0
  v_mov_b32 v183, 0
  v_mov_b32 v184, 0
  v_mov_b32 v185, 0
  v_mov_b32 v186, 0
  v_mov_b32 v187, 0
  v_mov_b32 v188, 0
  v_mov_b32 v189, 0
  v_mov_b32 v190, 0
  v_mov_b32 v191, 0
  v_mov_b32 v192, 0
  v_mov_b32 v193, 0
  v_mov_b32 v194, 0
  v_mov_b32 v195, 0
  v_mov_b32 v196, 0
  v_mov_b32 v197, 0
  v_mov_b32 v198, 0
  v_mov_b32 v199, 0
  v_mov_b32 v200, 0
  v_mov_b32 v201, 0
  v_mov_b32 v202, 0
  v_mov_b32 v203, 0
  v_mov_b32 v204, 0
  v_mov_b32 v205, 0
  v_mov_b32 v206, 0
  v_mov_b32 v207, 0
  v_mov_b32 v208, 0
  v_mov_b32 v209, 0
  v_mov_b32 v210, 0
  v_mov_b32 v211, 0
  v_mov_b32 v212, 0
  v_mov_b32 v213, 0
  v_mov_b32 v214, 0
  v_mov_b32 v215, 0
  v_mov_b32 v216, 0
  v_mov_b32 v217, 0
  v_mov_b32 v218, 0
  v_mov_b32 v219, 0
  v_mov_b32 v220, 0
  v_mov_b32 v221, 0
  v_mov_b32 v222, 0
  v_mov_b32 v223, 0
  v_mov_b32 v224, 0
  v_mov_b32 v225, 0
  v_mov_b32 v226, 0
  v_mov_b32 v227, 0
  v_mov_b32 v228, 0
  v_mov_b32 v229, 0
  v_mov_b32 v230, 0
  v_mov_b32 v231, 0
  v_mov_b32 v232, 0
  v_mov_b32 v233, 0
  v_mov_b32 v234, 0
  v_mov_b32 v235, 0
  v_mov_b32 v236, 0
  v_mov_b32 v237, 0
  v_mov_b32 v238, 0
  v_mov_b32 v239, 0
  v_mov_b32 v10, 0
  s_mov_b32 s47, s36
  s_mov_b32 s41, 0
L_slow_p2:
  s_add_u32 m0, s59, 0
  s_add_u32 s48, s47, 0
  buffer_load_dwordx4 v5, s[16:19], s48 offen lds
  s_add_u32 m0, s59, 1024
  s_add_u32 s48, s47, 2048
  buffer_load_dwordx4 v5, s[16:19], s48 offen lds
  s_add_u32 m0, s59, 2048
  s_add_u32 s48, s47, 4096
  buffer_load_dwordx4 v5, s[16:19], s48 offen lds
  s_add_u32 m0, s59, 3072
  s_add_u32 s48, s47, 6144
  buffer_load_dwordx4 v5, s[16:19], s48 offen lds
  s_add_u32 m0, s59, 4096
  s_add_u32 s48, s47, 128
  buffer_load_dwordx4 v5, s[16:19], s48 offen lds
  s_add_u32 m0, s59, 5120
  s_add_u32 s48, s47, 2176
  buffer_load_dwordx4 v5, s[16:19], s48 offen lds
  s_add_u32 m0, s59, 6144
  s_add_u32 s48, s47, 4224
  buffer_load_dwordx4 v5, s[16:19], s48 offen lds
  s_add_u32 m0, s59, 7168
  s_add_u32 s48, s47, 6272
  buffer_load_dwordx4 v5, s[16:19], s48 offen lds
  buffer_load_dwordx4 v[112:115], v4, s[12:15], s47 offen offset:0
  buffer_load_dwordx4 v[116:119], v4, s[12:15], s47 offen offset:32
  buffer_load_dwordx4 v[120:123], v4, s[12:15], s47 offen offset:64
  buffer_load_dwordx4 v[124:127], v4, s[12:15], s47 offen offset:96
  buffer_load_dwordx4 v[128:131], v4, s[12:15], s47 offen offset:128
  buffer_load_dwordx4 v[132:135], v4, s[12:15], s47 offen offset:160
  buffer_load_dwordx4 v[136:139], v4, s[12:15], s47 offen offset:192
  buffer_load_dwordx4 v[140:143], v4, s[12:15], s47 offen offset:224
  s_waitcnt vmcnt(0)
  v_mfma_f32_32x32x16_bf16 v[64:79], v[112:115], v[16:19], v[48:63]
  v_mfma_f32_32x32x16_bf16 v[64:79], v[116:119], v[20:23], v[64:79]
  v_mfma_f32_32x32x16_bf16 v[64:79], v[120:123], v[24:27], v[64:79]
  v_mfma_f32_32x32x16_bf16 v[64:79], v[124:127], v[28:31], v[64:79]
  v_mfma_f32_32x32x16_bf16 v[64:79], v[128:131], v[32:35], v[64:79]
  v_mfma_f32_32x32x16_bf16 v[64:79], v[132:135], v[36:39], v[64:79]
  v_mfma_f32_32x32x16_bf16 v[64:79], v[136:139], v[40:43], v[64:79]
  v_mfma_f32_32x32x16_bf16 v[64:79], v[140:143], v[44:47], v[64:79]
  s_nop 7
  s_nop 7
  ds_read_b64_tr_b16 v[144:145], v8 offset:0
  ds_read_b64_tr_b16 v[146:147], v8 offset:1024
  ds_read_b64_tr_b16 v[148:149], v9 offset:0
  ds_read_b64_tr_b16 v[150:151], v9 offset:1024
  ds_read_b64_tr_b16 v[152:153], v8 offset:4096
  ds_read_b64_tr_b16 v[154:155], v8 offset:5120
  ds_read_b64_tr_b16 v[156:157], v9 offset:4096
  ds_read_b64_tr_b16 v[158:159], v9 offset:5120
  s_waitcnt lgkmcnt(0)
  ds_read_b64_tr_b16 v[160:161], v8 offset:2048
  ds_read_b64_tr_b16 v[162:163], v8 offset:3072
  ds_read_b64_tr_b16 v[164:165], v9 offset:2048
  ds_read_b64_tr_b16 v[166:167], v9 offset:3072
  ds_read_b64_tr_b16 v[168:169], v8 offset:6144
  ds_read_b64_tr_b16 v[170:171], v8 offset:7168
  ds_read_b64_tr_b16 v[172:173], v9 offset:6144
  ds_read_b64_tr_b16 v[174:175], v9 offset:7168
  v_exp_f32 v64, v64
  v_exp_f32 v65, v65
  v_exp_f32 v66, v66
  v_exp_f32 v67, v67
  v_exp_f32 v68, v68
  v_exp_f32 v69, v69
  v_exp_f32 v70, v70
  v_exp_f32 v71, v71
  v_exp_f32 v72, v72
  v_exp_f32 v73, v73
  v_exp_f32 v74, v74
  v_exp_f32 v75, v75
  v_exp_f32 v76, v76
  v_exp_f32 v77, v77
  v_exp_f32 v78, v78
  v_exp_f32 v79, v79
  s_nop 0
  v_add_f32 v10, v10, v64
  v_add_f32 v10, v10, v65
  v_add_f32 v10, v10, v66
  v_add_f32 v10, v10, v67
  v_add_f32 v10, v10, v68
  v_add_f32 v10, v10, v69
  v_add_f32 v10, v10, v70
  v_add_f32 v10, v10, v71
  v_add_f32 v10, v10, v72
  v_add_f32 v10, v10, v73
  v_add_f32 v10, v10, v74
  v_add_f32 v10, v10, v75
  v_add_f32 v10, v10, v76
  v_add_f32 v10, v10, v77
  v_add_f32 v10, v10, v78
  v_add_f32 v10, v10, v79
  v_cvt_pk_bf16_f32 v96, v64, v65
  v_cvt_pk_bf16_f32 v97, v66, v67
  v_cvt_pk_bf16_f32 v98, v68, v69
  v_cvt_pk_bf16_f32 v99, v70, v71
  v_cvt_pk_bf16_f32 v100, v72, v73
  v_cvt_pk_bf16_f32 v101, v74, v75
  v_cvt_pk_bf16_f32 v102, v76, v77
  v_cvt_pk_bf16_f32 v103, v78, v79
  s_waitcnt lgkmcnt(0)
  s_nop 1
  v_mfma_f32_32x32x16_bf16 v[176:191], v[144:147], v[96:99], v[176:191]
  v_mfma_f32_32x32x16_bf16 v[192:207], v[148:151], v[96:99], v[192:207]
  v_mfma_f32_32x32x16_bf16 v[208:223], v[152:155], v[96:99], v[208:223]
  v_mfma_f32_32x32x16_bf16 v[224:239], v[156:159], v[96:99], v[224:239]
  v_mfma_f32_32x32x16_bf16 v[176:191], v[160:163], v[100:103], v[176:191]
  v_mfma_f32_32x32x16_bf16 v[192:207], v[164:167], v[100:103], v[192:207]
  v_mfma_f32_32x32x16_bf16 v[208:223], v[168:171], v[100:103], v[208:223]
  v_mfma_f32_32x32x16_bf16 v[224:239], v[172:175], v[100:103], v[224:239]
  s_add_u32 s47, s47, 0x2000
  s_add_u32 s41, s41, 1
  s_cmp_lt_u32 s41, 32
  s_cbranch_scc1 L_slow_p2
  v_mov_b32 v14, v10
  s_nop 1
  v_permlane32_swap_b32 v10, v14
  v_add_f32 v13, v10, v14
  v_rcp_f32 v15, v13
  s_nop 7
  s_nop 7
  v_mul_f32 v176, v176, v15
  v_mul_f32 v177, v177, v15
  v_mul_f32 v178, v178, v15
  v_mul_f32 v179, v179, v15
  v_mul_f32 v180, v180, v15
  v_mul_f32 v181, v181, v15
  v_mul_f32 v182, v182, v15
  v_mul_f32 v183, v183, v15
  v_cvt_pk_bf16_f32 v112, v176, v177
  v_cvt_pk_bf16_f32 v113, v178, v179
  v_cvt_pk_bf16_f32 v114, v180, v181
  v_cvt_pk_bf16_f32 v115, v182, v183
  s_nop 1
  v_permlane32_swap_b32 v112, v114
  v_permlane32_swap_b32 v113, v115
  v_mul_f32 v184, v184, v15
  v_mul_f32 v185, v185, v15
  v_mul_f32 v186, v186, v15
  v_mul_f32 v187, v187, v15
  v_mul_f32 v188, v188, v15
  v_mul_f32 v189, v189, v15
  v_mul_f32 v190, v190, v15
  v_mul_f32 v191, v191, v15
  v_cvt_pk_bf16_f32 v116, v184, v185
  v_cvt_pk_bf16_f32 v117, v186, v187
  v_cvt_pk_bf16_f32 v118, v188, v189
  v_cvt_pk_bf16_f32 v119, v190, v191
  s_nop 1
  v_permlane32_swap_b32 v116, v118
  v_permlane32_swap_b32 v117, v119
  v_mul_f32 v192, v192, v15
  v_mul_f32 v193, v193, v15
  v_mul_f32 v194, v194, v15
  v_mul_f32 v195, v195, v15
  v_mul_f32 v196, v196, v15
  v_mul_f32 v197, v197, v15
  v_mul_f32 v198, v198, v15
  v_mul_f32 v199, v199, v15
  v_cvt_pk_bf16_f32 v120, v192, v193
  v_cvt_pk_bf16_f32 v121, v194, v195
  v_cvt_pk_bf16_f32 v122, v196, v197
  v_cvt_pk_bf16_f32 v123, v198, v199
  s_nop 1
  v_permlane32_swap_b32 v120, v122
  v_permlane32_swap_b32 v121, v123
  v_mul_f32 v200, v200, v15
  v_mul_f32 v201, v201, v15
  v_mul_f32 v202, v202, v15
  v_mul_f32 v203, v203, v15
  v_mul_f32 v204, v204, v15
  v_mul_f32 v205, v205, v15
  v_mul_f32 v206, v206, v15
  v_mul_f32 v207, v207, v15
  v_cvt_pk_bf16_f32 v124, v200, v201
  v_cvt_pk_bf16_f32 v125, v202, v203
  v_cvt_pk_bf16_f32 v126, v204, v205
  v_cvt_pk_bf16_f32 v127, v206, v207
  s_nop 1
  v_permlane32_swap_b32 v124, v126
  v_permlane32_swap_b32 v125, v127
  v_mul_f32 v208, v208, v15
  v_mul_f32 v209, v209, v15
  v_mul_f32 v210, v210, v15
  v_mul_f32 v211, v211, v15
  v_mul_f32 v212, v212, v15
  v_mul_f32 v213, v213, v15
  v_mul_f32 v214, v214, v15
  v_mul_f32 v215, v215, v15
  v_cvt_pk_bf16_f32 v128, v208, v209
  v_cvt_pk_bf16_f32 v129, v210, v211
  v_cvt_pk_bf16_f32 v130, v212, v213
  v_cvt_pk_bf16_f32 v131, v214, v215
  s_nop 1
  v_permlane32_swap_b32 v128, v130
  v_permlane32_swap_b32 v129, v131
  v_mul_f32 v216, v216, v15
  v_mul_f32 v217, v217, v15
  v_mul_f32 v218, v218, v15
  v_mul_f32 v219, v219, v15
  v_mul_f32 v220, v220, v15
  v_mul_f32 v221, v221, v15
  v_mul_f32 v222, v222, v15
  v_mul_f32 v223, v223, v15
  v_cvt_pk_bf16_f32 v132, v216, v217
  v_cvt_pk_bf16_f32 v133, v218, v219
  v_cvt_pk_bf16_f32 v134, v220, v221
  v_cvt_pk_bf16_f32 v135, v222, v223
  s_nop 1
  v_permlane32_swap_b32 v132, v134
  v_permlane32_swap_b32 v133, v135
  v_mul_f32 v224, v224, v15
  v_mul_f32 v225, v225, v15
  v_mul_f32 v226, v226, v15
  v_mul_f32 v227, v227, v15
  v_mul_f32 v228, v228, v15
  v_mul_f32 v229, v229, v15
  v_mul_f32 v230, v230, v15
  v_mul_f32 v231, v231, v15
  v_cvt_pk_bf16_f32 v136, v224, v225
  v_cvt_pk_bf16_f32 v137, v226, v227
  v_cvt_pk_bf16_f32 v138, v228, v229
  v_cvt_pk_bf16_f32 v139, v230, v231
  s_nop 1
  v_permlane32_swap_b32 v136, v138
  v_permlane32_swap_b32 v137, v139
  v_mul_f32 v232, v232, v15
  v_mul_f32 v233, v233, v15
  v_mul_f32 v234, v234, v15
  v_mul_f32 v235, v235, v15
  v_mul_f32 v236, v236, v15
  v_mul_f32 v237, v237, v15
  v_mul_f32 v238, v238, v15
  v_mul_f32 v239, v239, v15
  v_cvt_pk_bf16_f32 v140, v232, v233
  v_cvt_pk_bf16_f32 v141, v234, v235
  v_cvt_pk_bf16_f32 v142, v236, v237
  v_cvt_pk_bf16_f32 v143, v238, v239
  s_nop 1
  v_permlane32_swap_b32 v140, v142
  v_permlane32_swap_b32 v141, v143
  s_mov_b64 exec, s[56:57]
  buffer_store_dwordx4 v[112:115], v12, s[20:23], s35 offen offset:0
  buffer_store_dwordx4 v[116:119], v12, s[20:23], s35 offen offset:32
  buffer_store_dwordx4 v[120:123], v12, s[20:23], s35 offen offset:64
  buffer_store_dwordx4 v[124:127], v12, s[20:23], s35 offen offset:96
  buffer_store_dwordx4 v[128:131], v12, s[20:23], s35 offen offset:128
  buffer_store_dwordx4 v[132:135], v12, s[20:23], s35 offen offset:160
  buffer_store_dwordx4 v[136:139], v12, s[20:23], s35 offen offset:192
  buffer_store_dwordx4 v[140:143], v12, s[20:23], s35 offen offset:224
  s_endpgm
.section .rodata,"a"
.p2align 6
.amdhsa_kernel standalone__gqa_softmax__near_ridge_kernel
  .amdhsa_next_free_vgpr 256
  .amdhsa_next_free_sgpr 80
  .amdhsa_accum_offset 256
  .amdhsa_group_segment_fixed_size 0
  .amdhsa_kernarg_size 48
  .amdhsa_user_sgpr_count 2
  .amdhsa_user_sgpr_kernarg_segment_ptr 1
  .amdhsa_system_sgpr_workgroup_id_x 1
.end_amdhsa_kernel
```
